```python
import torch

def _softmax(x, axis=-1):
    return torch.softmax(x, dim=axis)
def _gelu(x):
    return torch.nn.functional.gelu(x, approximate="tanh")
def _silu(x):
    return torch.nn.functional.silu(x)
def _sigmoid(x):
    return torch.sigmoid(x)
def _layernorm(x, axis=-1, eps=1e-5):
    m = x.mean(dim=axis, keepdim=True)
    v = x.var(dim=axis, keepdim=True, unbiased=False)
    return (x - m) / torch.sqrt(v + eps)
def _scatter_add(tgt, idx, src, axis=0):
    return tgt.clone().index_add_(axis, idx, src)
def _segment_sum(src, seg, n):
    out = torch.zeros((n,) + src.shape[1:], dtype=src.dtype)
    return out.index_add_(0, seg, src)
def _pad(x, pw):
    flat = tuple(v for pair in reversed(pw) for v in pair)
    return torch.nn.functional.pad(x, flat)

kernel_name = 'concat_heads__gqa_block_cached__gqa_block_cached__decode'

def setup_inputs():

    _w = (lambda a: (lambda t: t.to(torch.bfloat16) if t.is_floating_point() else t)(torch.as_tensor(a)))
    def _A_setup():
        B, Sq, D = 1, 1, 512
        Hq, Hkv, Sk, Dh = 32, 8, 65536, 128
        assert Hq % Hkv == 0, (Hq, Hkv)
        return {
            "x": _w((lambda *s: torch.randn(*s, dtype=torch.bfloat16) * 0.8)(B, Sq, D)),
            "k_cache": _w((lambda *s: torch.randn(*s, dtype=torch.bfloat16) * 1.6)(B, Hkv, Sk, Dh)),
            "v_cache": _w((lambda *s: torch.randn(*s, dtype=torch.bfloat16) * 0.2)(B, Hkv, Sk, Dh)),
            "wq": _w((lambda *s: torch.randn(*s, dtype=torch.bfloat16) * 1.6)(D, Hq * Dh) * (D ** -0.5)),
            "wo": _w((lambda *s: torch.randn(*s, dtype=torch.bfloat16) * 0.2)(Hq * Dh, D) * ((Hq * Dh) ** -0.5)),
        }
    _A_in = _A_setup()

    def _B_setup():
        B, Sq, D = 1, 1, 512
        Hq, Hkv, Sk, Dh = 32, 8, 65536, 128
        assert Hq % Hkv == 0, (Hq, Hkv)
        return {
            "x": _w((lambda *s: torch.randn(*s, dtype=torch.bfloat16) * 0.8)(B, Sq, D)),
            "k_cache": _w((lambda *s: torch.randn(*s, dtype=torch.bfloat16) * 1.6)(B, Hkv, Sk, Dh)),
            "v_cache": _w((lambda *s: torch.randn(*s, dtype=torch.bfloat16) * 0.2)(B, Hkv, Sk, Dh)),
            "wq": _w((lambda *s: torch.randn(*s, dtype=torch.bfloat16) * 1.6)(D, Hq * Dh) * (D ** -0.5)),
            "wo": _w((lambda *s: torch.randn(*s, dtype=torch.bfloat16) * 0.2)(Hq * Dh, D) * ((Hq * Dh) ** -0.5)),
        }
    _B_in = _B_setup()

    return {
        "A_x": _A_in["x"],
        "A_k_cache": _A_in["k_cache"],
        "A_v_cache": _A_in["v_cache"],
        "A_wq": _A_in["wq"],
        "A_wo": _A_in["wo"],
        "B_x": _B_in["x"],
        "B_k_cache": _B_in["k_cache"],
        "B_v_cache": _B_in["v_cache"],
        "B_wq": _B_in["wq"],
        "B_wo": _B_in["wo"],
    }

def reference(A_x, A_k_cache, A_v_cache, A_wq, A_wo, B_x, B_k_cache, B_v_cache, B_wq, B_wo):
    def _A_ref(x, k_cache, v_cache, wq, wo):
        B, Sq, D = x.shape
        Hq, Dh = 32, 128
        Hkv = k_cache.shape[1]
        rep = Hq // Hkv
        q = (lambda x, *d: x.permute(*d))((x @ wq).reshape(B, Sq, Hq, Dh), 0, 2, 1, 3)
        k = (lambda x, n, axis: torch.repeat_interleave(x, n, dim=axis))(k_cache, rep, axis=1)
        v = (lambda x, n, axis: torch.repeat_interleave(x, n, dim=axis))(v_cache, rep, axis=1)
        scores = torch.einsum("bhqd,bhkd->bhqk", q, k) * (Dh ** -0.5)
        p = _softmax(scores, axis=-1)
        o = torch.einsum("bhqk,bhkd->bhqd", p, v)
        return (lambda x, *d: x.permute(*d))(o, 0, 2, 1, 3).reshape(B, Sq, Hq * Dh) @ wo

    def _B_ref(x, k_cache, v_cache, wq, wo):
        B, Sq, D = x.shape
        Hq, Dh = 32, 128
        Hkv = k_cache.shape[1]
        rep = Hq // Hkv
        q = (lambda x, *d: x.permute(*d))((x @ wq).reshape(B, Sq, Hq, Dh), 0, 2, 1, 3)
        k = (lambda x, n, axis: torch.repeat_interleave(x, n, dim=axis))(k_cache, rep, axis=1)
        v = (lambda x, n, axis: torch.repeat_interleave(x, n, dim=axis))(v_cache, rep, axis=1)
        scores = torch.einsum("bhqd,bhkd->bhqk", q, k) * (Dh ** -0.5)
        p = _softmax(scores, axis=-1)
        o = torch.einsum("bhqk,bhkd->bhqd", p, v)
        return (lambda x, *d: x.permute(*d))(o, 0, 2, 1, 3).reshape(B, Sq, Hq * Dh) @ wo

    a = _A_ref(A_x, A_k_cache, A_v_cache, A_wq, A_wo)
    b = _B_ref(B_x, B_k_cache, B_v_cache, B_wq, B_wo)
    return torch.concatenate([a, b], axis=-1)
```

```asm
; @launch grid=(256,1,1) block=(320,1,1) lds=53248
.amdgcn_target "amdgcn-amd-amdhsa--gfx950"
.text
.globl concat_heads__gqa_block_cached__gqa_block_cached__decode_kernel
.p2align 8
.type concat_heads__gqa_block_cached__gqa_block_cached__decode_kernel,@function
concat_heads__gqa_block_cached__gqa_block_cached__decode_kernel:
  s_cmp_ge_u32 s2, 256
  s_cbranch_scc1 L_end
  s_load_dwordx2 s[4:5], s[0:1], 96
  v_lshrrev_b32 v1, 6, v0
  v_and_b32 v2, 63, v0
  v_readfirstlane_b32 s7, v1
  s_bfe_u32 s3, s2, 0x10004
  s_mul_i32 s8, s3, 40
  s_add_u32 s10, s0, s8
  s_addc_u32 s11, s1, 0
  s_lshr_b32 s8, s2, 5
  s_and_b32 s9, s2, 15
  s_cmp_lg_u32 s7, 0
  s_cbranch_scc1 L_stream
  s_load_dwordx2 s[20:21], s[10:11], 0
  s_load_dwordx2 s[24:25], s[10:11], 24
  v_lshrrev_b32 v12, 2, v2
  v_lshlrev_b32 v13, 6, v12
  v_and_b32 v14, 3, v2
  v_lshlrev_b32 v14, 4, v14
  v_lshl_add_u32 v14, v12, 18, v14
  s_and_b32 s28, s9, 7
  s_lshl_b32 s28, s28, 1
  s_lshr_b32 s29, s9, 3
  s_add_u32 s29, s29, s28
  s_lshl_b32 s28, s8, 4
  s_add_u32 s28, s28, s29
  s_lshl_b32 s28, s28, 6
  s_mov_b32 s22, 1024
  s_mov_b32 s23, 0x20000
  s_mov_b32 s26, 4194304
  s_mov_b32 s27, 0x20000
  s_waitcnt lgkmcnt(0)
  buffer_load_dwordx4 v[16:19], v13, s[20:23], 0 offen offset:0
  buffer_load_dwordx4 v[20:23], v13, s[20:23], 0 offen offset:16
  buffer_load_dwordx4 v[24:27], v13, s[20:23], 0 offen offset:32
  buffer_load_dwordx4 v[28:31], v13, s[20:23], 0 offen offset:48
  buffer_load_dwordx4 v[64:67], v14, s[24:27], s28 offen
  s_add_u32 s28, s28, 8192
  buffer_load_dwordx4 v[68:71], v14, s[24:27], s28 offen
  s_add_u32 s28, s28, 8192
  buffer_load_dwordx4 v[72:75], v14, s[24:27], s28 offen
  s_add_u32 s28, s28, 8192
  buffer_load_dwordx4 v[76:79], v14, s[24:27], s28 offen
  s_add_u32 s28, s28, 8192
  buffer_load_dwordx4 v[80:83], v14, s[24:27], s28 offen
  s_add_u32 s28, s28, 8192
  buffer_load_dwordx4 v[84:87], v14, s[24:27], s28 offen
  s_add_u32 s28, s28, 8192
  buffer_load_dwordx4 v[88:91], v14, s[24:27], s28 offen
  s_add_u32 s28, s28, 8192
  buffer_load_dwordx4 v[92:95], v14, s[24:27], s28 offen
  s_add_u32 s28, s28, 8192
  buffer_load_dwordx4 v[96:99], v14, s[24:27], s28 offen
  s_add_u32 s28, s28, 8192
  buffer_load_dwordx4 v[100:103], v14, s[24:27], s28 offen
  s_add_u32 s28, s28, 8192
  buffer_load_dwordx4 v[104:107], v14, s[24:27], s28 offen
  s_add_u32 s28, s28, 8192
  buffer_load_dwordx4 v[108:111], v14, s[24:27], s28 offen
  s_add_u32 s28, s28, 8192
  buffer_load_dwordx4 v[112:115], v14, s[24:27], s28 offen
  s_add_u32 s28, s28, 8192
  buffer_load_dwordx4 v[116:119], v14, s[24:27], s28 offen
  s_add_u32 s28, s28, 8192
  buffer_load_dwordx4 v[120:123], v14, s[24:27], s28 offen
  s_add_u32 s28, s28, 8192
  buffer_load_dwordx4 v[124:127], v14, s[24:27], s28 offen
  s_add_u32 s28, s28, 8192
  buffer_load_dwordx4 v[128:131], v14, s[24:27], s28 offen
  s_add_u32 s28, s28, 8192
  buffer_load_dwordx4 v[132:135], v14, s[24:27], s28 offen
  s_add_u32 s28, s28, 8192
  buffer_load_dwordx4 v[136:139], v14, s[24:27], s28 offen
  s_add_u32 s28, s28, 8192
  buffer_load_dwordx4 v[140:143], v14, s[24:27], s28 offen
  s_add_u32 s28, s28, 8192
  buffer_load_dwordx4 v[144:147], v14, s[24:27], s28 offen
  s_add_u32 s28, s28, 8192
  buffer_load_dwordx4 v[148:151], v14, s[24:27], s28 offen
  s_add_u32 s28, s28, 8192
  buffer_load_dwordx4 v[152:155], v14, s[24:27], s28 offen
  s_add_u32 s28, s28, 8192
  buffer_load_dwordx4 v[156:159], v14, s[24:27], s28 offen
  s_add_u32 s28, s28, 8192
  buffer_load_dwordx4 v[160:163], v14, s[24:27], s28 offen
  s_add_u32 s28, s28, 8192
  buffer_load_dwordx4 v[164:167], v14, s[24:27], s28 offen
  s_add_u32 s28, s28, 8192
  buffer_load_dwordx4 v[168:171], v14, s[24:27], s28 offen
  s_add_u32 s28, s28, 8192
  buffer_load_dwordx4 v[172:175], v14, s[24:27], s28 offen
  s_add_u32 s28, s28, 8192
  buffer_load_dwordx4 v[176:179], v14, s[24:27], s28 offen
  s_add_u32 s28, s28, 8192
  buffer_load_dwordx4 v[180:183], v14, s[24:27], s28 offen
  s_add_u32 s28, s28, 8192
  buffer_load_dwordx4 v[184:187], v14, s[24:27], s28 offen
  s_add_u32 s28, s28, 8192
  buffer_load_dwordx4 v[188:191], v14, s[24:27], s28 offen
  s_barrier
  s_load_dword s6, s[4:5], 0
  v_mov_b32 v13, 0
  s_and_b32 s30, s2, 31
  s_cmp_lg_u32 s30, 0
  s_cbranch_scc1 L_nocnt
  s_lshl_b32 s30, s8, 9
  s_add_u32 s30, s30, 65536
  v_lshl_add_u32 v12, v2, 8, s30
  s_mov_b64 exec, 3
  global_store_dword v12, v13, s[4:5] sc1
  s_mov_b64 exec, -1
L_nocnt:
  ds_write_b32 v13, v13 offset:2560
  v_lshlrev_b32 v12, 2, v2
  v_mov_b32 v15, -1
  ds_write_b32 v12, v15 offset:3200
  ds_write_b32 v12, v15 offset:3456
  ds_write_b32 v12, v15 offset:3712
  v_and_b32 v7, 1, v2
  v_lshlrev_b32 v7, 4, v7
  v_mov_b32 v6, 0xffff
  v_lshlrev_b32 v7, v7, v6
  v_bfe_i32 v6, v2, 1, 1
  v_and_b32 v6, v6, v7
  v_xor_b32 v5, v7, v6
  s_mov_b32 s40, 0x01000100
  s_mov_b32 s41, 0x03020302
  v_mov_b32 v7, 0x0c0c0c0c
  v_bfi_b32 v8, v5, s40, v7
  v_bfi_b32 v9, v6, s40, v7
  v_bfi_b32 v10, v5, s41, v7
  v_bfi_b32 v11, v6, s41, v7
  s_waitcnt vmcnt(32)
  v_perm_b32 v40, v16, v16, v8
  v_perm_b32 v41, v16, v16, v9
  v_perm_b32 v42, v16, v16, v10
  v_perm_b32 v43, v16, v16, v11
  v_perm_b32 v44, v17, v17, v8
  v_perm_b32 v45, v17, v17, v9
  s_waitcnt vmcnt(31)
  v_mfma_f32_16x16x16_bf16 v[32:35], v[40:41], v[64:65], 0
  v_mfma_f32_16x16x16_bf16 v[36:39], v[40:41], v[66:67], 0
  v_perm_b32 v46, v17, v17, v10
  v_perm_b32 v47, v17, v17, v11
  s_waitcnt vmcnt(30)
  v_mfma_f32_16x16x16_bf16 v[32:35], v[42:43], v[68:69], v[32:35]
  v_mfma_f32_16x16x16_bf16 v[36:39], v[42:43], v[70:71], v[36:39]
  v_perm_b32 v40, v18, v18, v8
  v_perm_b32 v41, v18, v18, v9
  s_waitcnt vmcnt(29)
  v_mfma_f32_16x16x16_bf16 v[32:35], v[44:45], v[72:73], v[32:35]
  v_mfma_f32_16x16x16_bf16 v[36:39], v[44:45], v[74:75], v[36:39]
  v_perm_b32 v42, v18, v18, v10
  v_perm_b32 v43, v18, v18, v11
  s_waitcnt vmcnt(28)
  v_mfma_f32_16x16x16_bf16 v[32:35], v[46:47], v[76:77], v[32:35]
  v_mfma_f32_16x16x16_bf16 v[36:39], v[46:47], v[78:79], v[36:39]
  v_perm_b32 v44, v19, v19, v8
  v_perm_b32 v45, v19, v19, v9
  s_waitcnt vmcnt(27)
  v_mfma_f32_16x16x16_bf16 v[32:35], v[40:41], v[80:81], v[32:35]
  v_mfma_f32_16x16x16_bf16 v[36:39], v[40:41], v[82:83], v[36:39]
  v_perm_b32 v46, v19, v19, v10
  v_perm_b32 v47, v19, v19, v11
  s_waitcnt vmcnt(26)
  v_mfma_f32_16x16x16_bf16 v[32:35], v[42:43], v[84:85], v[32:35]
  v_mfma_f32_16x16x16_bf16 v[36:39], v[42:43], v[86:87], v[36:39]
  v_perm_b32 v40, v20, v20, v8
  v_perm_b32 v41, v20, v20, v9
  s_waitcnt vmcnt(25)
  v_mfma_f32_16x16x16_bf16 v[32:35], v[44:45], v[88:89], v[32:35]
  v_mfma_f32_16x16x16_bf16 v[36:39], v[44:45], v[90:91], v[36:39]
  v_perm_b32 v42, v20, v20, v10
  v_perm_b32 v43, v20, v20, v11
  s_waitcnt vmcnt(24)
  v_mfma_f32_16x16x16_bf16 v[32:35], v[46:47], v[92:93], v[32:35]
  v_mfma_f32_16x16x16_bf16 v[36:39], v[46:47], v[94:95], v[36:39]
  v_perm_b32 v44, v21, v21, v8
  v_perm_b32 v45, v21, v21, v9
  s_waitcnt vmcnt(23)
  v_mfma_f32_16x16x16_bf16 v[32:35], v[40:41], v[96:97], v[32:35]
  v_mfma_f32_16x16x16_bf16 v[36:39], v[40:41], v[98:99], v[36:39]
  v_perm_b32 v46, v21, v21, v10
  v_perm_b32 v47, v21, v21, v11
  s_waitcnt vmcnt(22)
  v_mfma_f32_16x16x16_bf16 v[32:35], v[42:43], v[100:101], v[32:35]
  v_mfma_f32_16x16x16_bf16 v[36:39], v[42:43], v[102:103], v[36:39]
  v_perm_b32 v40, v22, v22, v8
  v_perm_b32 v41, v22, v22, v9
  s_waitcnt vmcnt(21)
  v_mfma_f32_16x16x16_bf16 v[32:35], v[44:45], v[104:105], v[32:35]
  v_mfma_f32_16x16x16_bf16 v[36:39], v[44:45], v[106:107], v[36:39]
  v_perm_b32 v42, v22, v22, v10
  v_perm_b32 v43, v22, v22, v11
  s_waitcnt vmcnt(20)
  v_mfma_f32_16x16x16_bf16 v[32:35], v[46:47], v[108:109], v[32:35]
  v_mfma_f32_16x16x16_bf16 v[36:39], v[46:47], v[110:111], v[36:39]
  v_perm_b32 v44, v23, v23, v8
  v_perm_b32 v45, v23, v23, v9
  s_waitcnt vmcnt(19)
  v_mfma_f32_16x16x16_bf16 v[32:35], v[40:41], v[112:113], v[32:35]
  v_mfma_f32_16x16x16_bf16 v[36:39], v[40:41], v[114:115], v[36:39]
  v_perm_b32 v46, v23, v23, v10
  v_perm_b32 v47, v23, v23, v11
  s_waitcnt vmcnt(18)
  v_mfma_f32_16x16x16_bf16 v[32:35], v[42:43], v[116:117], v[32:35]
  v_mfma_f32_16x16x16_bf16 v[36:39], v[42:43], v[118:119], v[36:39]
  v_perm_b32 v40, v24, v24, v8
  v_perm_b32 v41, v24, v24, v9
  s_waitcnt vmcnt(17)
  v_mfma_f32_16x16x16_bf16 v[32:35], v[44:45], v[120:121], v[32:35]
  v_mfma_f32_16x16x16_bf16 v[36:39], v[44:45], v[122:123], v[36:39]
  v_perm_b32 v42, v24, v24, v10
  v_perm_b32 v43, v24, v24, v11
  s_waitcnt vmcnt(16)
  v_mfma_f32_16x16x16_bf16 v[32:35], v[46:47], v[124:125], v[32:35]
  v_mfma_f32_16x16x16_bf16 v[36:39], v[46:47], v[126:127], v[36:39]
  v_perm_b32 v44, v25, v25, v8
  v_perm_b32 v45, v25, v25, v9
  s_waitcnt vmcnt(15)
  v_mfma_f32_16x16x16_bf16 v[32:35], v[40:41], v[128:129], v[32:35]
  v_mfma_f32_16x16x16_bf16 v[36:39], v[40:41], v[130:131], v[36:39]
  v_perm_b32 v46, v25, v25, v10
  v_perm_b32 v47, v25, v25, v11
  s_waitcnt vmcnt(14)
  v_mfma_f32_16x16x16_bf16 v[32:35], v[42:43], v[132:133], v[32:35]
  v_mfma_f32_16x16x16_bf16 v[36:39], v[42:43], v[134:135], v[36:39]
  v_perm_b32 v40, v26, v26, v8
  v_perm_b32 v41, v26, v26, v9
  s_waitcnt vmcnt(13)
  v_mfma_f32_16x16x16_bf16 v[32:35], v[44:45], v[136:137], v[32:35]
  v_mfma_f32_16x16x16_bf16 v[36:39], v[44:45], v[138:139], v[36:39]
  v_perm_b32 v42, v26, v26, v10
  v_perm_b32 v43, v26, v26, v11
  s_waitcnt vmcnt(12)
  v_mfma_f32_16x16x16_bf16 v[32:35], v[46:47], v[140:141], v[32:35]
  v_mfma_f32_16x16x16_bf16 v[36:39], v[46:47], v[142:143], v[36:39]
  v_perm_b32 v44, v27, v27, v8
  v_perm_b32 v45, v27, v27, v9
  s_waitcnt vmcnt(11)
  v_mfma_f32_16x16x16_bf16 v[32:35], v[40:41], v[144:145], v[32:35]
  v_mfma_f32_16x16x16_bf16 v[36:39], v[40:41], v[146:147], v[36:39]
  v_perm_b32 v46, v27, v27, v10
  v_perm_b32 v47, v27, v27, v11
  s_waitcnt vmcnt(10)
  v_mfma_f32_16x16x16_bf16 v[32:35], v[42:43], v[148:149], v[32:35]
  v_mfma_f32_16x16x16_bf16 v[36:39], v[42:43], v[150:151], v[36:39]
  v_perm_b32 v40, v28, v28, v8
  v_perm_b32 v41, v28, v28, v9
  s_waitcnt vmcnt(9)
  v_mfma_f32_16x16x16_bf16 v[32:35], v[44:45], v[152:153], v[32:35]
  v_mfma_f32_16x16x16_bf16 v[36:39], v[44:45], v[154:155], v[36:39]
  v_perm_b32 v42, v28, v28, v10
  v_perm_b32 v43, v28, v28, v11
  s_waitcnt vmcnt(8)
  v_mfma_f32_16x16x16_bf16 v[32:35], v[46:47], v[156:157], v[32:35]
  v_mfma_f32_16x16x16_bf16 v[36:39], v[46:47], v[158:159], v[36:39]
  v_perm_b32 v44, v29, v29, v8
  v_perm_b32 v45, v29, v29, v9
  s_waitcnt vmcnt(7)
  v_mfma_f32_16x16x16_bf16 v[32:35], v[40:41], v[160:161], v[32:35]
  v_mfma_f32_16x16x16_bf16 v[36:39], v[40:41], v[162:163], v[36:39]
  v_perm_b32 v46, v29, v29, v10
  v_perm_b32 v47, v29, v29, v11
  s_waitcnt vmcnt(6)
  v_mfma_f32_16x16x16_bf16 v[32:35], v[42:43], v[164:165], v[32:35]
  v_mfma_f32_16x16x16_bf16 v[36:39], v[42:43], v[166:167], v[36:39]
  v_perm_b32 v40, v30, v30, v8
  v_perm_b32 v41, v30, v30, v9
  s_waitcnt vmcnt(5)
  v_mfma_f32_16x16x16_bf16 v[32:35], v[44:45], v[168:169], v[32:35]
  v_mfma_f32_16x16x16_bf16 v[36:39], v[44:45], v[170:171], v[36:39]
  v_perm_b32 v42, v30, v30, v10
  v_perm_b32 v43, v30, v30, v11
  s_waitcnt vmcnt(4)
  v_mfma_f32_16x16x16_bf16 v[32:35], v[46:47], v[172:173], v[32:35]
  v_mfma_f32_16x16x16_bf16 v[36:39], v[46:47], v[174:175], v[36:39]
  v_perm_b32 v44, v31, v31, v8
  v_perm_b32 v45, v31, v31, v9
  s_waitcnt vmcnt(3)
  v_mfma_f32_16x16x16_bf16 v[32:35], v[40:41], v[176:177], v[32:35]
  v_mfma_f32_16x16x16_bf16 v[36:39], v[40:41], v[178:179], v[36:39]
  v_perm_b32 v46, v31, v31, v10
  v_perm_b32 v47, v31, v31, v11
  s_waitcnt vmcnt(2)
  v_mfma_f32_16x16x16_bf16 v[32:35], v[42:43], v[180:181], v[32:35]
  v_mfma_f32_16x16x16_bf16 v[36:39], v[42:43], v[182:183], v[36:39]
  s_waitcnt vmcnt(1)
  v_mfma_f32_16x16x16_bf16 v[32:35], v[44:45], v[184:185], v[32:35]
  v_mfma_f32_16x16x16_bf16 v[36:39], v[44:45], v[186:187], v[36:39]
  s_waitcnt vmcnt(0)
  v_mfma_f32_16x16x16_bf16 v[32:35], v[46:47], v[188:189], v[32:35]
  v_mfma_f32_16x16x16_bf16 v[36:39], v[46:47], v[190:191], v[36:39]
  v_and_b32 v12, 15, v2
  v_lshlrev_b32 v12, 5, v12
  v_lshlrev_b32 v13, 4, v2
  s_lshl_b32 s28, s8, 12
  s_add_u32 s28, s28, 4096
  v_add_u32 v15, s28, v13
  s_lshl_b32 s29, s29, 7
  s_lshl_b32 s30, s3, 11
  s_add_u32 s29, s29, s30
  v_add_u32 v14, s29, v15
  s_mov_b32 exec_lo, 0x00f0000f
  s_mov_b32 exec_hi, 0xf0000f00
  ds_write_b128 v12, v[32:35] offset:0
  ds_write_b128 v12, v[36:39] offset:16
  s_mov_b64 exec, 0xff
  ds_read_b128 v[16:19], v13 offset:0
  ds_read_b128 v[20:23], v13 offset:128
  ds_read_b128 v[24:27], v13 offset:256
  ds_read_b128 v[28:31], v13 offset:384
  s_waitcnt lgkmcnt(0)
  s_add_u32 s6, s6, 0x9e3779b1
  v_add_f32 v16, v16, v20
  v_add_f32 v24, v24, v28
  v_add_f32 v17, v17, v21
  v_add_f32 v25, v25, v29
  v_add_f32 v18, v18, v22
  v_add_f32 v26, v26, v30
  v_add_f32 v19, v19, v23
  v_add_f32 v27, v27, v31
  v_add_f32 v16, v16, v24
  v_add_f32 v17, v17, v25
  v_add_f32 v18, v18, v26
  v_add_f32 v19, v19, v27
  v_cvt_pk_bf16_f32 v20, v16, v17
  v_mov_b32 v21, s6
  v_cvt_pk_bf16_f32 v22, v18, v19
  v_mov_b32 v23, s6
  global_store_dwordx4 v14, v[20:23], s[4:5] sc1
  s_mov_b64 exec, -1
  s_mov_b32 s36, 131072
  s_and_b32 s30, s2, 0x38
  s_cmp_lg_u32 s30, 0
  s_cbranch_scc1 L_nopf
  s_getpc_b64 s[30:31]
L_pfpc:
  s_sub_u32 s30, s30, L_pfpc-concat_heads__gqa_block_cached__gqa_block_cached__decode_kernel
  s_subb_u32 s31, s31, 0
  v_lshlrev_b32 v3, 7, v2
  v_cmp_gt_u32 vcc, L_codeend-concat_heads__gqa_block_cached__gqa_block_cached__decode_kernel, v3
  s_and_b64 exec, exec, vcc
  s_cbranch_execz L_pfdone
  global_load_dword v62, v3, s[30:31]
  v_add_u32 v3, 0x2000, v3
  v_cmp_gt_u32 vcc, L_codeend-concat_heads__gqa_block_cached__gqa_block_cached__decode_kernel, v3
  s_and_b64 exec, exec, vcc
  s_cbranch_execz L_pfdone
  global_load_dword v62, v3, s[30:31]
  v_add_u32 v3, 0x2000, v3
  v_cmp_gt_u32 vcc, L_codeend-concat_heads__gqa_block_cached__gqa_block_cached__decode_kernel, v3
  s_and_b64 exec, exec, vcc
  s_cbranch_execz L_pfdone
  global_load_dword v62, v3, s[30:31]
  v_add_u32 v3, 0x2000, v3
  v_cmp_gt_u32 vcc, L_codeend-concat_heads__gqa_block_cached__gqa_block_cached__decode_kernel, v3
  s_and_b64 exec, exec, vcc
  s_cbranch_execz L_pfdone
  global_load_dword v62, v3, s[30:31]
  v_add_u32 v3, 0x2000, v3
L_pfdone:
  s_mov_b64 exec, -1
L_nopf:
  s_sleep 48
L_pollq:
  global_load_dwordx4 v[32:35], v15, s[4:5] offset:0 sc1
  global_load_dwordx4 v[36:39], v15, s[4:5] offset:1024 sc1
  global_load_dwordx4 v[40:43], v15, s[4:5] offset:2048 sc1
  global_load_dwordx4 v[44:47], v15, s[4:5] offset:3072 sc1
  s_sub_u32 s36, s36, 1
  s_cbranch_scc1 L_end
  v_mov_b32 v48, 0
  s_waitcnt vmcnt(3)
  v_xor_b32 v49, s6, v33
  v_xor_b32 v50, s6, v35
  v_or3_b32 v48, v48, v49, v50
  s_waitcnt vmcnt(2)
  v_xor_b32 v49, s6, v37
  v_xor_b32 v50, s6, v39
  v_or3_b32 v48, v48, v49, v50
  s_waitcnt vmcnt(1)
  v_xor_b32 v49, s6, v41
  v_xor_b32 v50, s6, v43
  v_or3_b32 v48, v48, v49, v50
  s_waitcnt vmcnt(0)
  v_xor_b32 v49, s6, v45
  v_xor_b32 v50, s6, v47
  v_or3_b32 v48, v48, v49, v50
  v_cmpx_ne_u32 vcc, 0, v48
  s_cbranch_execnz L_pollq
  s_mov_b64 exec, -1
  v_lshlrev_b32 v13, 3, v2
  v_mov_b32 v33, v34
  ds_write_b64 v13, v[32:33] offset:512
  v_mov_b32 v37, v38
  ds_write_b64 v13, v[36:37] offset:1024
  v_mov_b32 v41, v42
  ds_write_b64 v13, v[40:41] offset:1536
  v_mov_b32 v45, v46
  ds_write_b64 v13, v[44:45] offset:2048
  s_waitcnt lgkmcnt(0)
  s_barrier
  s_lshl_b32 s30, s8, 9
  s_add_u32 s30, s30, 65536
  s_and_b32 s29, s2, 4
  s_lshl_b32 s29, s29, 6
  s_add_u32 s30, s30, s29
  s_add_u32 s44, s4, s30
  s_addc_u32 s45, s5, 0
  v_mov_b32 v14, 1
  s_mov_b64 exec, 1
  v_mov_b32 v12, 0
  v_mov_b32 v13, 0
  s_mov_b32 s34, 1
  s_mov_b32 s36, 1048576
L_agent:
  s_sleep 1
  ds_read_b32 v3, v12 offset:2560
  s_sub_u32 s36, s36, 1
  s_cbranch_scc1 L_end
  s_waitcnt lgkmcnt(0)
  v_cmp_gt_u32 vcc, s34, v3
  s_cbranch_vccnz L_agent
  global_atomic_add v3, v12, v14, s[44:45] sc0
  s_add_u32 s34, s34, 4
  s_waitcnt vmcnt(0)
  v_add_u32 v3, 16, v3
  ds_write_b32 v13, v3 offset:3200
  v_readfirstlane_b32 s38, v3
  v_add_u32 v13, 4, v13
  s_cmp_lt_u32 s38, 64
  s_cbranch_scc1 L_agent
  s_waitcnt lgkmcnt(0)
L_end:
  s_endpgm
L_stream:
  s_load_dwordx4 s[12:15], s[0:1], 8
  s_load_dwordx4 s[16:19], s[0:1], 48
  s_load_dwordx2 s[46:47], s[0:1], 80
  s_load_dwordx2 s[48:49], s[10:11], 32
  s_sub_u32 s7, s7, 1
  v_subrev_u32 v0, 64, v0
  s_mov_b32 s33, 0
  s_mov_b32 s34, 0
  s_bitcmp1_b32 s7, 0
  s_cselect_b32 s29, 0x221500, 0
  s_xor_b32 s34, s34, s29
  s_bitcmp1_b32 s7, 1
  s_cselect_b32 s29, 0x6bef00, 0
  s_xor_b32 s34, s34, s29
  s_bitcmp1_b32 s2, 5
  s_cselect_b32 s29, 0x410600, 0
  s_xor_b32 s33, s33, s29
  s_bitcmp1_b32 s2, 6
  s_cselect_b32 s29, 0x4c7500, 0
  s_xor_b32 s33, s33, s29
  s_bitcmp1_b32 s2, 7
  s_cselect_b32 s29, 0x675c00, 0
  s_xor_b32 s33, s33, s29
  s_bitcmp1_b32 s2, 0
  s_cselect_b32 s29, 0xbbf900, 0
  s_xor_b32 s34, s34, s29
  s_bitcmp1_b32 s2, 1
  s_cselect_b32 s29, 0x951c00, 0
  s_xor_b32 s34, s34, s29
  s_bitcmp1_b32 s2, 2
  s_cselect_b32 s29, 0x82d500, 0
  s_xor_b32 s33, s33, s29
  s_bitcmp1_b32 s2, 3
  s_cselect_b32 s29, 0x486e00, 0
  s_xor_b32 s34, s34, s29
  s_bitcmp1_b32 s2, 4
  s_cselect_b32 s29, 0x5bfd00, 0
  s_xor_b32 s34, s34, s29
  s_xor_b32 s34, s34, s33
  v_mov_b32 v20, s34
  v_bfe_i32 v7, v2, 0, 1
  v_and_b32 v7, 0xc84700, v7
  v_xor_b32 v20, v7, v20
  v_bfe_i32 v7, v2, 1, 1
  v_and_b32 v7, 0x1a100, v7
  v_xor_b32 v20, v7, v20
  v_bfe_i32 v7, v2, 2, 1
  v_and_b32 v7, 0x4bd100, v7
  v_xor_b32 v20, v7, v20
  v_bfe_i32 v7, v2, 3, 1
  v_and_b32 v7, 0xb1b200, v7
  v_xor_b32 v20, v7, v20
  v_bfe_i32 v7, v2, 4, 1
  v_and_b32 v7, 0x811300, v7
  v_xor_b32 v20, v7, v20
  v_and_b32 v8, 3, v2
  v_lshlrev_b32 v8, 4, v8
  v_lshrrev_b32 v7, 4, v2
  v_lshl_add_u32 v8, v7, 6, v8
  v_bfe_i32 v7, v2, 2, 1
  v_and_b32 v7, 0x229400, v7
  v_xor_b32 v8, v7, v8
  v_bfe_i32 v7, v2, 3, 1
  v_and_b32 v7, 0x200200, v7
  v_xor_b32 v8, v7, v8
  v_xor_b32 v9, 0x31500, v8
  v_xor_b32 v10, 0x21500, v8
  v_xor_b32 v11, 0x10000, v8
  s_lshl_b32 s29, s8, 24
  s_mov_b32 s22, 16777216
  s_mov_b32 s23, 0x20000
  s_mov_b32 s26, 16777216
  s_mov_b32 s27, 0x20000
  s_mov_b32 s32, 0
  s_waitcnt lgkmcnt(0)
  s_add_u32 s20, s12, s29
  s_addc_u32 s21, s13, 0
  v_readlane_b32 s28, v20, s32
  s_add_u32 s32, s32, 1
  s_nop 0
  v_xor_b32 v3, s28, v8
  s_barrier
  buffer_load_dwordx4 v[64:67], v3, s[20:23], 0 offen nt
  v_xor_b32 v3, s28, v9
  buffer_load_dwordx4 v[68:71], v3, s[20:23], 0 offen nt
  v_xor_b32 v3, s28, v10
  buffer_load_dwordx4 v[72:75], v3, s[20:23], 0 offen nt
  v_xor_b32 v3, s28, v11
  buffer_load_dwordx4 v[76:79], v3, s[20:23], 0 offen nt
  v_readlane_b32 s28, v20, s32
  s_add_u32 s32, s32, 1
  s_nop 0
  v_xor_b32 v3, s28, v8
  buffer_load_dwordx4 v[80:83], v3, s[20:23], 0 offen nt
  s_load_dword s6, s[4:5], 0
  s_add_u32 s14, s14, s29
  s_addc_u32 s15, s15, 0
  s_add_u32 s16, s16, s29
  s_addc_u32 s17, s17, 0
  s_add_u32 s18, s18, s29
  s_addc_u32 s19, s19, 0
  s_mov_b32 s24, s16
  s_mov_b32 s25, s17
  v_and_b32 v7, 1, v2
  v_lshlrev_b32 v7, 4, v7
  v_mov_b32 v6, 0xffff
  v_lshlrev_b32 v7, v7, v6
  v_bfe_i32 v6, v2, 1, 1
  v_and_b32 v6, v6, v7
  v_xor_b32 v5, v7, v6
  v_and_b32 v12, 15, v2
  v_lshlrev_b32 v12, 4, v12
  v_lshrrev_b32 v4, 4, v2
  v_lshl_add_u32 v43, v4, 13, v12
  v_bfe_i32 v7, v2, 4, 1
  v_and_b32 v7, 0x229400, v7
  v_xor_b32 v12, v7, v12
  v_bfe_i32 v7, v2, 5, 1
  v_and_b32 v7, 0x200200, v7
  v_xor_b32 v12, v7, v12
  v_xor_b32 v13, 0x31500, v12
  v_xor_b32 v14, 0x21500, v12
  v_xor_b32 v15, 0x10000, v12
  v_mov_b32 v16, v8
  v_mov_b32 v17, v9
  v_mov_b32 v18, v10
  v_mov_b32 v19, v11
  s_xor_b32 s33, s33, 0x7b7000
  v_mov_b32 v21, s33
  v_bfe_i32 v7, v2, 0, 1
  v_and_b32 v7, 0xbbf900, v7
  v_xor_b32 v21, v7, v21
  v_bfe_i32 v7, v2, 1, 1
  v_and_b32 v7, 0x951c00, v7
  v_xor_b32 v21, v7, v21
  v_bfe_i32 v7, v2, 2, 1
  v_and_b32 v7, 0x486e00, v7
  v_xor_b32 v21, v7, v21
  v_bfe_i32 v7, v2, 3, 1
  v_and_b32 v7, 0x5bfd00, v7
  v_xor_b32 v21, v7, v21
  v_bfe_i32 v7, v2, 4, 1
  v_and_b32 v7, 0xc84700, v7
  v_xor_b32 v21, v7, v21
  v_bfe_i32 v7, v2, 5, 1
  v_and_b32 v7, 0x1a100, v7
  v_xor_b32 v21, v7, v21
  s_mov_b32 s37, 1040356334
  v_mov_b32 v36, 0xff7fffff
  v_mov_b32 v38, 0
  v_mov_b32 v28, 0
  v_mov_b32 v29, 0
  v_mov_b32 v30, 0
  v_mov_b32 v31, 0
  v_mov_b32 v32, 0
  v_mov_b32 v33, 0
  v_mov_b32 v34, 0
  v_mov_b32 v35, 0
  v_lshlrev_b32 v42, 4, v2
  s_lshl_b32 s30, s7, 13
  v_add_u32 v42, s30, v42
  s_mov_b32 s52, 0x22222222
  s_mov_b32 s53, 0x22222222
  s_mov_b32 s54, 0x44444444
  s_mov_b32 s55, 0x44444444
  s_mov_b32 s56, 0x88888888
  s_mov_b32 s57, 0x88888888
  s_mov_b32 s50, 4194304
  s_mov_b32 s51, 0x20000
  s_lshl_b32 s35, s8, 4
  s_add_u32 s35, s35, s9
  s_lshl_b32 s35, s35, 15
  s_lshl_b32 s30, s7, 8
  s_add_u32 s35, s35, s30
  v_bfe_u32 v1, v2, 2, 2
  v_lshlrev_b32 v1, 8, v1
  v_lshl_add_u32 v1, v4, 6, v1
  v_and_b32 v7, 3, v2
  v_lshl_add_u32 v1, v7, 4, v1
  v_xor_b32 v3, s28, v9
  s_waitcnt vmcnt(4)
  buffer_load_dwordx4 v[84:87], v3, s[20:23], 0 offen nt
  v_xor_b32 v3, s28, v10
  s_waitcnt vmcnt(4)
  buffer_load_dwordx4 v[88:91], v3, s[20:23], 0 offen nt
  v_xor_b32 v3, s28, v11
  s_waitcnt vmcnt(4)
  buffer_load_dwordx4 v[92:95], v3, s[20:23], 0 offen nt
  v_readlane_b32 s28, v20, s32
  s_add_u32 s32, s32, 1
  s_nop 0
  v_xor_b32 v3, s28, v8
  s_waitcnt vmcnt(4)
  buffer_load_dwordx4 v[96:99], v3, s[20:23], 0 offen nt
  v_xor_b32 v3, s28, v9
  s_waitcnt vmcnt(4)
  buffer_load_dwordx4 v[100:103], v3, s[20:23], 0 offen nt
  v_xor_b32 v3, s28, v10
  s_waitcnt vmcnt(4)
  buffer_load_dwordx4 v[104:107], v3, s[20:23], 0 offen nt
  v_xor_b32 v3, s28, v11
  s_waitcnt vmcnt(4)
  buffer_load_dwordx4 v[108:111], v3, s[20:23], 0 offen nt
  v_readlane_b32 s28, v20, s32
  s_add_u32 s32, s32, 1
  s_nop 0
  v_xor_b32 v3, s28, v8
  s_waitcnt vmcnt(4)
  buffer_load_dwordx4 v[112:115], v3, s[20:23], 0 offen nt
  v_xor_b32 v3, s28, v9
  s_waitcnt vmcnt(4)
  buffer_load_dwordx4 v[116:119], v3, s[20:23], 0 offen nt
  v_xor_b32 v3, s28, v10
  s_waitcnt vmcnt(4)
  buffer_load_dwordx4 v[120:123], v3, s[20:23], 0 offen nt
  v_xor_b32 v3, s28, v11
  s_waitcnt vmcnt(4)
  buffer_load_dwordx4 v[124:127], v3, s[20:23], 0 offen nt
  v_readlane_b32 s28, v20, s32
  s_add_u32 s32, s32, 1
  s_nop 0
  v_xor_b32 v3, s28, v8
  s_waitcnt vmcnt(4)
  buffer_load_dwordx4 v[128:131], v3, s[20:23], 0 offen nt
  v_xor_b32 v3, s28, v9
  s_waitcnt vmcnt(4)
  buffer_load_dwordx4 v[132:135], v3, s[20:23], 0 offen nt
  v_xor_b32 v3, s28, v10
  s_waitcnt vmcnt(4)
  buffer_load_dwordx4 v[136:139], v3, s[20:23], 0 offen nt
  v_xor_b32 v3, s28, v11
  s_waitcnt vmcnt(4)
  buffer_load_dwordx4 v[140:143], v3, s[20:23], 0 offen nt
  v_readlane_b32 s28, v20, s32
  s_add_u32 s32, s32, 1
  s_nop 0
  v_xor_b32 v3, s28, v8
  s_waitcnt vmcnt(4)
  buffer_load_dwordx4 v[144:147], v3, s[20:23], 0 offen nt
  v_xor_b32 v3, s28, v9
  s_waitcnt vmcnt(4)
  buffer_load_dwordx4 v[148:151], v3, s[20:23], 0 offen nt
  v_xor_b32 v3, s28, v10
  s_waitcnt vmcnt(4)
  buffer_load_dwordx4 v[152:155], v3, s[20:23], 0 offen nt
  v_xor_b32 v3, s28, v11
  s_waitcnt vmcnt(4)
  buffer_load_dwordx4 v[156:159], v3, s[20:23], 0 offen nt
  v_readlane_b32 s28, v20, s32
  s_add_u32 s32, s32, 1
  s_nop 0
  v_xor_b32 v3, s28, v8
  s_waitcnt vmcnt(4)
  buffer_load_dwordx4 v[160:163], v3, s[20:23], 0 offen nt
  v_xor_b32 v3, s28, v9
  s_waitcnt vmcnt(4)
  buffer_load_dwordx4 v[164:167], v3, s[20:23], 0 offen nt
  v_xor_b32 v3, s28, v10
  s_waitcnt vmcnt(4)
  buffer_load_dwordx4 v[168:171], v3, s[20:23], 0 offen nt
  v_xor_b32 v3, s28, v11
  s_waitcnt vmcnt(4)
  buffer_load_dwordx4 v[172:175], v3, s[20:23], 0 offen nt
  v_readlane_b32 s28, v20, s32
  s_add_u32 s32, s32, 1
  s_nop 0
  v_xor_b32 v3, s28, v8
  s_waitcnt vmcnt(4)
  buffer_load_dwordx4 v[176:179], v3, s[20:23], 0 offen nt
  v_xor_b32 v3, s28, v9
  s_waitcnt vmcnt(4)
  buffer_load_dwordx4 v[180:183], v3, s[20:23], 0 offen nt
  v_xor_b32 v3, s28, v10
  s_waitcnt vmcnt(4)
  buffer_load_dwordx4 v[184:187], v3, s[20:23], 0 offen nt
  v_xor_b32 v3, s28, v11
  s_waitcnt vmcnt(4)
  buffer_load_dwordx4 v[188:191], v3, s[20:23], 0 offen nt
  v_readlane_b32 s28, v20, s32
  s_add_u32 s32, s32, 1
  s_nop 0
  v_xor_b32 v3, s28, v8
  s_waitcnt vmcnt(4)
  buffer_load_dwordx4 v[192:195], v3, s[20:23], 0 offen nt
  v_xor_b32 v3, s28, v9
  s_waitcnt vmcnt(4)
  buffer_load_dwordx4 v[196:199], v3, s[20:23], 0 offen nt
  v_xor_b32 v3, s28, v10
  s_waitcnt vmcnt(4)
  buffer_load_dwordx4 v[200:203], v3, s[20:23], 0 offen nt
  v_xor_b32 v3, s28, v11
  s_waitcnt vmcnt(4)
  buffer_load_dwordx4 v[204:207], v3, s[20:23], 0 offen nt
  v_readlane_b32 s28, v20, s32
  s_add_u32 s32, s32, 1
  s_nop 0
  v_xor_b32 v3, s28, v8
  s_waitcnt vmcnt(4)
  buffer_load_dwordx4 v[208:211], v3, s[20:23], 0 offen nt
  v_xor_b32 v3, s28, v9
  s_waitcnt vmcnt(4)
  buffer_load_dwordx4 v[212:215], v3, s[20:23], 0 offen nt
  v_xor_b32 v3, s28, v10
  s_waitcnt vmcnt(4)
  buffer_load_dwordx4 v[216:219], v3, s[20:23], 0 offen nt
  v_xor_b32 v3, s28, v11
  s_waitcnt vmcnt(4)
  buffer_load_dwordx4 v[220:223], v3, s[20:23], 0 offen nt
  v_readlane_b32 s28, v20, s32
  s_add_u32 s32, s32, 1
  s_nop 0
  v_xor_b32 v3, s28, v8
  s_waitcnt vmcnt(4)
  buffer_load_dwordx4 v[224:227], v3, s[20:23], 0 offen nt
  v_xor_b32 v3, s28, v9
  s_waitcnt vmcnt(4)
  buffer_load_dwordx4 v[228:231], v3, s[20:23], 0 offen nt
  v_xor_b32 v3, s28, v10
  s_waitcnt vmcnt(4)
  buffer_load_dwordx4 v[232:235], v3, s[20:23], 0 offen nt
  v_xor_b32 v3, s28, v11
  s_waitcnt vmcnt(4)
  buffer_load_dwordx4 v[236:239], v3, s[20:23], 0 offen nt
  v_readlane_b32 s28, v20, s32
  s_add_u32 s32, s32, 1
  s_nop 0
  v_xor_b32 v3, s28, v8
  s_waitcnt vmcnt(4)
  buffer_load_dwordx4 v[240:243], v3, s[20:23], 0 offen nt
  v_xor_b32 v3, s28, v9
  s_waitcnt vmcnt(4)
  buffer_load_dwordx4 v[244:247], v3, s[20:23], 0 offen nt
  v_xor_b32 v3, s28, v10
  s_waitcnt vmcnt(4)
  buffer_load_dwordx4 v[248:251], v3, s[20:23], 0 offen nt
  v_xor_b32 v3, s28, v11
  s_waitcnt vmcnt(4)
  buffer_load_dwordx4 v[252:255], v3, s[20:23], 0 offen nt
  s_barrier
  ds_read_b128 v[24:27], v1 offset:512
  s_mov_b32 s42, 0
  s_waitcnt lgkmcnt(0)
  s_add_u32 s6, s6, 0x9e3779b1
  v_readlane_b32 s28, v20, s32
  s_add_u32 s32, s32, 1
  v_mfma_f32_16x16x32_bf16 v[44:47], v[64:67], v[24:27], 0
  v_mfma_f32_16x16x32_bf16 v[48:51], v[128:131], v[24:27], 0
  v_xor_b32 v3, s28, v16
  s_waitcnt vmcnt(4)
  buffer_load_dwordx4 v[64:67], v3, s[20:23], 0 offen nt
  s_nop 3
  v_mov_b32_dpp v41, v44 quad_perm:[0,0,0,0] row_mask:0xf bank_mask:0xf
  v_add_f32_dpp v41, v45, v41 quad_perm:[1,1,1,1] row_mask:0xf bank_mask:0xf
  v_add_f32_dpp v41, v46, v41 quad_perm:[2,2,2,2] row_mask:0xf bank_mask:0xf
  v_add_f32_dpp v52, v47, v41 quad_perm:[3,3,3,3] row_mask:0xf bank_mask:0xf
  v_mov_b32_dpp v41, v48 quad_perm:[0,0,0,0] row_mask:0xf bank_mask:0xf
  v_add_f32_dpp v41, v49, v41 quad_perm:[1,1,1,1] row_mask:0xf bank_mask:0xf
  v_add_f32_dpp v41, v50, v41 quad_perm:[2,2,2,2] row_mask:0xf bank_mask:0xf
  v_add_f32_dpp v56, v51, v41 quad_perm:[3,3,3,3] row_mask:0xf bank_mask:0xf
  v_mfma_f32_16x16x32_bf16 v[44:47], v[68:71], v[24:27], 0
  v_mfma_f32_16x16x32_bf16 v[48:51], v[132:135], v[24:27], 0
  v_xor_b32 v3, s28, v17
  s_waitcnt vmcnt(4)
  buffer_load_dwordx4 v[68:71], v3, s[20:23], 0 offen nt
  s_nop 3
  v_mov_b32_dpp v41, v44 quad_perm:[0,0,0,0] row_mask:0xf bank_mask:0xf
  v_add_f32_dpp v41, v45, v41 quad_perm:[1,1,1,1] row_mask:0xf bank_mask:0xf
  v_add_f32_dpp v41, v46, v41 quad_perm:[2,2,2,2] row_mask:0xf bank_mask:0xf
  v_add_f32_dpp v41, v47, v41 quad_perm:[3,3,3,3] row_mask:0xf bank_mask:0xf
  v_cndmask_b32 v52, v52, v41, s[52:53]
  v_mov_b32_dpp v41, v48 quad_perm:[0,0,0,0] row_mask:0xf bank_mask:0xf
  v_add_f32_dpp v41, v49, v41 quad_perm:[1,1,1,1] row_mask:0xf bank_mask:0xf
  v_add_f32_dpp v41, v50, v41 quad_perm:[2,2,2,2] row_mask:0xf bank_mask:0xf
  v_add_f32_dpp v41, v51, v41 quad_perm:[3,3,3,3] row_mask:0xf bank_mask:0xf
  v_cndmask_b32 v56, v56, v41, s[52:53]
  v_mfma_f32_16x16x32_bf16 v[44:47], v[72:75], v[24:27], 0
  v_mfma_f32_16x16x32_bf16 v[48:51], v[136:139], v[24:27], 0
  v_xor_b32 v3, s28, v18
  s_waitcnt vmcnt(4)
  buffer_load_dwordx4 v[72:75], v3, s[20:23], 0 offen nt
  s_nop 3
  v_mov_b32_dpp v41, v44 quad_perm:[0,0,0,0] row_mask:0xf bank_mask:0xf
  v_add_f32_dpp v41, v45, v41 quad_perm:[1,1,1,1] row_mask:0xf bank_mask:0xf
  v_add_f32_dpp v41, v46, v41 quad_perm:[2,2,2,2] row_mask:0xf bank_mask:0xf
  v_add_f32_dpp v41, v47, v41 quad_perm:[3,3,3,3] row_mask:0xf bank_mask:0xf
  v_cndmask_b32 v52, v52, v41, s[54:55]
  v_mov_b32_dpp v41, v48 quad_perm:[0,0,0,0] row_mask:0xf bank_mask:0xf
  v_add_f32_dpp v41, v49, v41 quad_perm:[1,1,1,1] row_mask:0xf bank_mask:0xf
  v_add_f32_dpp v41, v50, v41 quad_perm:[2,2,2,2] row_mask:0xf bank_mask:0xf
  v_add_f32_dpp v41, v51, v41 quad_perm:[3,3,3,3] row_mask:0xf bank_mask:0xf
  v_cndmask_b32 v56, v56, v41, s[54:55]
  v_mfma_f32_16x16x32_bf16 v[44:47], v[76:79], v[24:27], 0
  v_mfma_f32_16x16x32_bf16 v[48:51], v[140:143], v[24:27], 0
  v_xor_b32 v3, s28, v19
  s_waitcnt vmcnt(4)
  buffer_load_dwordx4 v[76:79], v3, s[20:23], 0 offen nt
  s_nop 3
  v_mov_b32_dpp v41, v44 quad_perm:[0,0,0,0] row_mask:0xf bank_mask:0xf
  v_add_f32_dpp v41, v45, v41 quad_perm:[1,1,1,1] row_mask:0xf bank_mask:0xf
  v_add_f32_dpp v41, v46, v41 quad_perm:[2,2,2,2] row_mask:0xf bank_mask:0xf
  v_add_f32_dpp v41, v47, v41 quad_perm:[3,3,3,3] row_mask:0xf bank_mask:0xf
  v_cndmask_b32 v52, v52, v41, s[56:57]
  v_mov_b32_dpp v41, v48 quad_perm:[0,0,0,0] row_mask:0xf bank_mask:0xf
  v_add_f32_dpp v41, v49, v41 quad_perm:[1,1,1,1] row_mask:0xf bank_mask:0xf
  v_add_f32_dpp v41, v50, v41 quad_perm:[2,2,2,2] row_mask:0xf bank_mask:0xf
  v_add_f32_dpp v41, v51, v41 quad_perm:[3,3,3,3] row_mask:0xf bank_mask:0xf
  v_cndmask_b32 v56, v56, v41, s[56:57]
  v_readlane_b32 s28, v20, s32
  s_add_u32 s32, s32, 1
  v_mfma_f32_16x16x32_bf16 v[44:47], v[80:83], v[24:27], 0
  v_mfma_f32_16x16x32_bf16 v[48:51], v[144:147], v[24:27], 0
  v_xor_b32 v3, s28, v16
  s_waitcnt vmcnt(4)
  buffer_load_dwordx4 v[80:83], v3, s[20:23], 0 offen nt
  s_nop 3
  v_mov_b32_dpp v41, v44 quad_perm:[0,0,0,0] row_mask:0xf bank_mask:0xf
  v_add_f32_dpp v41, v45, v41 quad_perm:[1,1,1,1] row_mask:0xf bank_mask:0xf
  v_add_f32_dpp v41, v46, v41 quad_perm:[2,2,2,2] row_mask:0xf bank_mask:0xf
  v_add_f32_dpp v53, v47, v41 quad_perm:[3,3,3,3] row_mask:0xf bank_mask:0xf
  v_mov_b32_dpp v41, v48 quad_perm:[0,0,0,0] row_mask:0xf bank_mask:0xf
  v_add_f32_dpp v41, v49, v41 quad_perm:[1,1,1,1] row_mask:0xf bank_mask:0xf
  v_add_f32_dpp v41, v50, v41 quad_perm:[2,2,2,2] row_mask:0xf bank_mask:0xf
  v_add_f32_dpp v57, v51, v41 quad_perm:[3,3,3,3] row_mask:0xf bank_mask:0xf
  v_mfma_f32_16x16x32_bf16 v[44:47], v[84:87], v[24:27], 0
  v_mfma_f32_16x16x32_bf16 v[48:51], v[148:151], v[24:27], 0
  v_xor_b32 v3, s28, v17
  s_waitcnt vmcnt(4)
  buffer_load_dwordx4 v[84:87], v3, s[20:23], 0 offen nt
  s_nop 3
  v_mov_b32_dpp v41, v44 quad_perm:[0,0,0,0] row_mask:0xf bank_mask:0xf
  v_add_f32_dpp v41, v45, v41 quad_perm:[1,1,1,1] row_mask:0xf bank_mask:0xf
  v_add_f32_dpp v41, v46, v41 quad_perm:[2,2,2,2] row_mask:0xf bank_mask:0xf
  v_add_f32_dpp v41, v47, v41 quad_perm:[3,3,3,3] row_mask:0xf bank_mask:0xf
  v_cndmask_b32 v53, v53, v41, s[52:53]
  v_mov_b32_dpp v41, v48 quad_perm:[0,0,0,0] row_mask:0xf bank_mask:0xf
  v_add_f32_dpp v41, v49, v41 quad_perm:[1,1,1,1] row_mask:0xf bank_mask:0xf
  v_add_f32_dpp v41, v50, v41 quad_perm:[2,2,2,2] row_mask:0xf bank_mask:0xf
  v_add_f32_dpp v41, v51, v41 quad_perm:[3,3,3,3] row_mask:0xf bank_mask:0xf
  v_cndmask_b32 v57, v57, v41, s[52:53]
  v_mfma_f32_16x16x32_bf16 v[44:47], v[88:91], v[24:27], 0
  v_mfma_f32_16x16x32_bf16 v[48:51], v[152:155], v[24:27], 0
  v_xor_b32 v3, s28, v18
  s_waitcnt vmcnt(4)
  buffer_load_dwordx4 v[88:91], v3, s[20:23], 0 offen nt
  s_nop 3
  v_mov_b32_dpp v41, v44 quad_perm:[0,0,0,0] row_mask:0xf bank_mask:0xf
  v_add_f32_dpp v41, v45, v41 quad_perm:[1,1,1,1] row_mask:0xf bank_mask:0xf
  v_add_f32_dpp v41, v46, v41 quad_perm:[2,2,2,2] row_mask:0xf bank_mask:0xf
  v_add_f32_dpp v41, v47, v41 quad_perm:[3,3,3,3] row_mask:0xf bank_mask:0xf
  v_cndmask_b32 v53, v53, v41, s[54:55]
  v_mov_b32_dpp v41, v48 quad_perm:[0,0,0,0] row_mask:0xf bank_mask:0xf
  v_add_f32_dpp v41, v49, v41 quad_perm:[1,1,1,1] row_mask:0xf bank_mask:0xf
  v_add_f32_dpp v41, v50, v41 quad_perm:[2,2,2,2] row_mask:0xf bank_mask:0xf
  v_add_f32_dpp v41, v51, v41 quad_perm:[3,3,3,3] row_mask:0xf bank_mask:0xf
  v_cndmask_b32 v57, v57, v41, s[54:55]
  v_mfma_f32_16x16x32_bf16 v[44:47], v[92:95], v[24:27], 0
  v_mfma_f32_16x16x32_bf16 v[48:51], v[156:159], v[24:27], 0
  v_xor_b32 v3, s28, v19
  s_waitcnt vmcnt(4)
  buffer_load_dwordx4 v[92:95], v3, s[20:23], 0 offen nt
  s_nop 3
  v_mov_b32_dpp v41, v44 quad_perm:[0,0,0,0] row_mask:0xf bank_mask:0xf
  v_add_f32_dpp v41, v45, v41 quad_perm:[1,1,1,1] row_mask:0xf bank_mask:0xf
  v_add_f32_dpp v41, v46, v41 quad_perm:[2,2,2,2] row_mask:0xf bank_mask:0xf
  v_add_f32_dpp v41, v47, v41 quad_perm:[3,3,3,3] row_mask:0xf bank_mask:0xf
  v_cndmask_b32 v53, v53, v41, s[56:57]
  v_mov_b32_dpp v41, v48 quad_perm:[0,0,0,0] row_mask:0xf bank_mask:0xf
  v_add_f32_dpp v41, v49, v41 quad_perm:[1,1,1,1] row_mask:0xf bank_mask:0xf
  v_add_f32_dpp v41, v50, v41 quad_perm:[2,2,2,2] row_mask:0xf bank_mask:0xf
  v_add_f32_dpp v41, v51, v41 quad_perm:[3,3,3,3] row_mask:0xf bank_mask:0xf
  v_cndmask_b32 v57, v57, v41, s[56:57]
  v_readlane_b32 s28, v20, s32
  s_add_u32 s32, s32, 1
  v_mfma_f32_16x16x32_bf16 v[44:47], v[96:99], v[24:27], 0
  v_mfma_f32_16x16x32_bf16 v[48:51], v[160:163], v[24:27], 0
  v_xor_b32 v3, s28, v16
  s_waitcnt vmcnt(4)
  buffer_load_dwordx4 v[96:99], v3, s[20:23], 0 offen nt
  s_nop 3
  v_mov_b32_dpp v41, v44 quad_perm:[0,0,0,0] row_mask:0xf bank_mask:0xf
  v_add_f32_dpp v41, v45, v41 quad_perm:[1,1,1,1] row_mask:0xf bank_mask:0xf
  v_add_f32_dpp v41, v46, v41 quad_perm:[2,2,2,2] row_mask:0xf bank_mask:0xf
  v_add_f32_dpp v54, v47, v41 quad_perm:[3,3,3,3] row_mask:0xf bank_mask:0xf
  v_mov_b32_dpp v41, v48 quad_perm:[0,0,0,0] row_mask:0xf bank_mask:0xf
  v_add_f32_dpp v41, v49, v41 quad_perm:[1,1,1,1] row_mask:0xf bank_mask:0xf
  v_add_f32_dpp v41, v50, v41 quad_perm:[2,2,2,2] row_mask:0xf bank_mask:0xf
  v_add_f32_dpp v58, v51, v41 quad_perm:[3,3,3,3] row_mask:0xf bank_mask:0xf
  v_mfma_f32_16x16x32_bf16 v[44:47], v[100:103], v[24:27], 0
  v_mfma_f32_16x16x32_bf16 v[48:51], v[164:167], v[24:27], 0
  v_xor_b32 v3, s28, v17
  s_waitcnt vmcnt(4)
  buffer_load_dwordx4 v[100:103], v3, s[20:23], 0 offen nt
  s_nop 3
  v_mov_b32_dpp v41, v44 quad_perm:[0,0,0,0] row_mask:0xf bank_mask:0xf
  v_add_f32_dpp v41, v45, v41 quad_perm:[1,1,1,1] row_mask:0xf bank_mask:0xf
  v_add_f32_dpp v41, v46, v41 quad_perm:[2,2,2,2] row_mask:0xf bank_mask:0xf
  v_add_f32_dpp v41, v47, v41 quad_perm:[3,3,3,3] row_mask:0xf bank_mask:0xf
  v_cndmask_b32 v54, v54, v41, s[52:53]
  v_mov_b32_dpp v41, v48 quad_perm:[0,0,0,0] row_mask:0xf bank_mask:0xf
  v_add_f32_dpp v41, v49, v41 quad_perm:[1,1,1,1] row_mask:0xf bank_mask:0xf
  v_add_f32_dpp v41, v50, v41 quad_perm:[2,2,2,2] row_mask:0xf bank_mask:0xf
  v_add_f32_dpp v41, v51, v41 quad_perm:[3,3,3,3] row_mask:0xf bank_mask:0xf
  v_cndmask_b32 v58, v58, v41, s[52:53]
  v_mfma_f32_16x16x32_bf16 v[44:47], v[104:107], v[24:27], 0
  v_mfma_f32_16x16x32_bf16 v[48:51], v[168:171], v[24:27], 0
  v_xor_b32 v3, s28, v18
  s_waitcnt vmcnt(4)
  buffer_load_dwordx4 v[104:107], v3, s[20:23], 0 offen nt
  s_nop 3
  v_mov_b32_dpp v41, v44 quad_perm:[0,0,0,0] row_mask:0xf bank_mask:0xf
  v_add_f32_dpp v41, v45, v41 quad_perm:[1,1,1,1] row_mask:0xf bank_mask:0xf
  v_add_f32_dpp v41, v46, v41 quad_perm:[2,2,2,2] row_mask:0xf bank_mask:0xf
  v_add_f32_dpp v41, v47, v41 quad_perm:[3,3,3,3] row_mask:0xf bank_mask:0xf
  v_cndmask_b32 v54, v54, v41, s[54:55]
  v_mov_b32_dpp v41, v48 quad_perm:[0,0,0,0] row_mask:0xf bank_mask:0xf
  v_add_f32_dpp v41, v49, v41 quad_perm:[1,1,1,1] row_mask:0xf bank_mask:0xf
  v_add_f32_dpp v41, v50, v41 quad_perm:[2,2,2,2] row_mask:0xf bank_mask:0xf
  v_add_f32_dpp v41, v51, v41 quad_perm:[3,3,3,3] row_mask:0xf bank_mask:0xf
  v_cndmask_b32 v58, v58, v41, s[54:55]
  v_mfma_f32_16x16x32_bf16 v[44:47], v[108:111], v[24:27], 0
  v_mfma_f32_16x16x32_bf16 v[48:51], v[172:175], v[24:27], 0
  v_xor_b32 v3, s28, v19
  s_waitcnt vmcnt(4)
  buffer_load_dwordx4 v[108:111], v3, s[20:23], 0 offen nt
  s_nop 3
  v_mov_b32_dpp v41, v44 quad_perm:[0,0,0,0] row_mask:0xf bank_mask:0xf
  v_add_f32_dpp v41, v45, v41 quad_perm:[1,1,1,1] row_mask:0xf bank_mask:0xf
  v_add_f32_dpp v41, v46, v41 quad_perm:[2,2,2,2] row_mask:0xf bank_mask:0xf
  v_add_f32_dpp v41, v47, v41 quad_perm:[3,3,3,3] row_mask:0xf bank_mask:0xf
  v_cndmask_b32 v54, v54, v41, s[56:57]
  v_mov_b32_dpp v41, v48 quad_perm:[0,0,0,0] row_mask:0xf bank_mask:0xf
  v_add_f32_dpp v41, v49, v41 quad_perm:[1,1,1,1] row_mask:0xf bank_mask:0xf
  v_add_f32_dpp v41, v50, v41 quad_perm:[2,2,2,2] row_mask:0xf bank_mask:0xf
  v_add_f32_dpp v41, v51, v41 quad_perm:[3,3,3,3] row_mask:0xf bank_mask:0xf
  v_cndmask_b32 v58, v58, v41, s[56:57]
  v_readlane_b32 s28, v20, s32
  s_add_u32 s32, s32, 1
  v_mfma_f32_16x16x32_bf16 v[44:47], v[112:115], v[24:27], 0
  v_mfma_f32_16x16x32_bf16 v[48:51], v[176:179], v[24:27], 0
  v_xor_b32 v3, s28, v16
  s_waitcnt vmcnt(4)
  buffer_load_dwordx4 v[112:115], v3, s[20:23], 0 offen nt
  s_nop 3
  v_mov_b32_dpp v41, v44 quad_perm:[0,0,0,0] row_mask:0xf bank_mask:0xf
  v_add_f32_dpp v41, v45, v41 quad_perm:[1,1,1,1] row_mask:0xf bank_mask:0xf
  v_add_f32_dpp v41, v46, v41 quad_perm:[2,2,2,2] row_mask:0xf bank_mask:0xf
  v_add_f32_dpp v55, v47, v41 quad_perm:[3,3,3,3] row_mask:0xf bank_mask:0xf
  v_mov_b32_dpp v41, v48 quad_perm:[0,0,0,0] row_mask:0xf bank_mask:0xf
  v_add_f32_dpp v41, v49, v41 quad_perm:[1,1,1,1] row_mask:0xf bank_mask:0xf
  v_add_f32_dpp v41, v50, v41 quad_perm:[2,2,2,2] row_mask:0xf bank_mask:0xf
  v_add_f32_dpp v59, v51, v41 quad_perm:[3,3,3,3] row_mask:0xf bank_mask:0xf
  v_mfma_f32_16x16x32_bf16 v[44:47], v[116:119], v[24:27], 0
  v_mfma_f32_16x16x32_bf16 v[48:51], v[180:183], v[24:27], 0
  v_xor_b32 v3, s28, v17
  s_waitcnt vmcnt(4)
  buffer_load_dwordx4 v[116:119], v3, s[20:23], 0 offen nt
  s_nop 3
  v_mov_b32_dpp v41, v44 quad_perm:[0,0,0,0] row_mask:0xf bank_mask:0xf
  v_add_f32_dpp v41, v45, v41 quad_perm:[1,1,1,1] row_mask:0xf bank_mask:0xf
  v_add_f32_dpp v41, v46, v41 quad_perm:[2,2,2,2] row_mask:0xf bank_mask:0xf
  v_add_f32_dpp v41, v47, v41 quad_perm:[3,3,3,3] row_mask:0xf bank_mask:0xf
  v_cndmask_b32 v55, v55, v41, s[52:53]
  v_mov_b32_dpp v41, v48 quad_perm:[0,0,0,0] row_mask:0xf bank_mask:0xf
  v_add_f32_dpp v41, v49, v41 quad_perm:[1,1,1,1] row_mask:0xf bank_mask:0xf
  v_add_f32_dpp v41, v50, v41 quad_perm:[2,2,2,2] row_mask:0xf bank_mask:0xf
  v_add_f32_dpp v41, v51, v41 quad_perm:[3,3,3,3] row_mask:0xf bank_mask:0xf
  v_cndmask_b32 v59, v59, v41, s[52:53]
  v_mfma_f32_16x16x32_bf16 v[44:47], v[120:123], v[24:27], 0
  v_mfma_f32_16x16x32_bf16 v[48:51], v[184:187], v[24:27], 0
  v_xor_b32 v3, s28, v18
  s_waitcnt vmcnt(4)
  buffer_load_dwordx4 v[120:123], v3, s[20:23], 0 offen nt
  s_nop 3
  v_mov_b32_dpp v41, v44 quad_perm:[0,0,0,0] row_mask:0xf bank_mask:0xf
  v_add_f32_dpp v41, v45, v41 quad_perm:[1,1,1,1] row_mask:0xf bank_mask:0xf
  v_add_f32_dpp v41, v46, v41 quad_perm:[2,2,2,2] row_mask:0xf bank_mask:0xf
  v_add_f32_dpp v41, v47, v41 quad_perm:[3,3,3,3] row_mask:0xf bank_mask:0xf
  v_cndmask_b32 v55, v55, v41, s[54:55]
  v_mov_b32_dpp v41, v48 quad_perm:[0,0,0,0] row_mask:0xf bank_mask:0xf
  v_add_f32_dpp v41, v49, v41 quad_perm:[1,1,1,1] row_mask:0xf bank_mask:0xf
  v_add_f32_dpp v41, v50, v41 quad_perm:[2,2,2,2] row_mask:0xf bank_mask:0xf
  v_add_f32_dpp v41, v51, v41 quad_perm:[3,3,3,3] row_mask:0xf bank_mask:0xf
  v_cndmask_b32 v59, v59, v41, s[54:55]
  v_mfma_f32_16x16x32_bf16 v[44:47], v[124:127], v[24:27], 0
  v_mfma_f32_16x16x32_bf16 v[48:51], v[188:191], v[24:27], 0
  v_xor_b32 v3, s28, v19
  s_waitcnt vmcnt(4)
  buffer_load_dwordx4 v[124:127], v3, s[20:23], 0 offen nt
  s_nop 3
  v_mov_b32_dpp v41, v44 quad_perm:[0,0,0,0] row_mask:0xf bank_mask:0xf
  v_add_f32_dpp v41, v45, v41 quad_perm:[1,1,1,1] row_mask:0xf bank_mask:0xf
  v_add_f32_dpp v41, v46, v41 quad_perm:[2,2,2,2] row_mask:0xf bank_mask:0xf
  v_add_f32_dpp v41, v47, v41 quad_perm:[3,3,3,3] row_mask:0xf bank_mask:0xf
  v_cndmask_b32 v55, v55, v41, s[56:57]
  v_mov_b32_dpp v41, v48 quad_perm:[0,0,0,0] row_mask:0xf bank_mask:0xf
  v_add_f32_dpp v41, v49, v41 quad_perm:[1,1,1,1] row_mask:0xf bank_mask:0xf
  v_add_f32_dpp v41, v50, v41 quad_perm:[2,2,2,2] row_mask:0xf bank_mask:0xf
  v_add_f32_dpp v41, v51, v41 quad_perm:[3,3,3,3] row_mask:0xf bank_mask:0xf
  v_cndmask_b32 v59, v59, v41, s[56:57]
  v_max3_f32 v36, v36, v52, v53
  v_max3_f32 v36, v36, v54, v55
  ds_write_b128 v42, v[52:55] offset:20480
  v_max3_f32 v36, v36, v56, v57
  v_max3_f32 v36, v36, v58, v59
  ds_write_b128 v42, v[56:59] offset:21504
  v_readlane_b32 s28, v20, s32
  s_add_u32 s32, s32, 1
  v_mfma_f32_16x16x32_bf16 v[44:47], v[64:67], v[24:27], 0
  v_mfma_f32_16x16x32_bf16 v[48:51], v[192:195], v[24:27], 0
  v_xor_b32 v3, s28, v16
  s_waitcnt vmcnt(4)
  buffer_load_dwordx4 v[64:67], v3, s[20:23], 0 offen nt
  s_nop 3
  v_mov_b32_dpp v41, v44 quad_perm:[0,0,0,0] row_mask:0xf bank_mask:0xf
  v_add_f32_dpp v41, v45, v41 quad_perm:[1,1,1,1] row_mask:0xf bank_mask:0xf
  v_add_f32_dpp v41, v46, v41 quad_perm:[2,2,2,2] row_mask:0xf bank_mask:0xf
  v_add_f32_dpp v52, v47, v41 quad_perm:[3,3,3,3] row_mask:0xf bank_mask:0xf
  v_mov_b32_dpp v41, v48 quad_perm:[0,0,0,0] row_mask:0xf bank_mask:0xf
  v_add_f32_dpp v41, v49, v41 quad_perm:[1,1,1,1] row_mask:0xf bank_mask:0xf
  v_add_f32_dpp v41, v50, v41 quad_perm:[2,2,2,2] row_mask:0xf bank_mask:0xf
  v_add_f32_dpp v56, v51, v41 quad_perm:[3,3,3,3] row_mask:0xf bank_mask:0xf
  v_mfma_f32_16x16x32_bf16 v[44:47], v[68:71], v[24:27], 0
  v_mfma_f32_16x16x32_bf16 v[48:51], v[196:199], v[24:27], 0
  v_xor_b32 v3, s28, v17
  s_waitcnt vmcnt(4)
  buffer_load_dwordx4 v[68:71], v3, s[20:23], 0 offen nt
  s_nop 3
  v_mov_b32_dpp v41, v44 quad_perm:[0,0,0,0] row_mask:0xf bank_mask:0xf
  v_add_f32_dpp v41, v45, v41 quad_perm:[1,1,1,1] row_mask:0xf bank_mask:0xf
  v_add_f32_dpp v41, v46, v41 quad_perm:[2,2,2,2] row_mask:0xf bank_mask:0xf
  v_add_f32_dpp v41, v47, v41 quad_perm:[3,3,3,3] row_mask:0xf bank_mask:0xf
  v_cndmask_b32 v52, v52, v41, s[52:53]
  v_mov_b32_dpp v41, v48 quad_perm:[0,0,0,0] row_mask:0xf bank_mask:0xf
  v_add_f32_dpp v41, v49, v41 quad_perm:[1,1,1,1] row_mask:0xf bank_mask:0xf
  v_add_f32_dpp v41, v50, v41 quad_perm:[2,2,2,2] row_mask:0xf bank_mask:0xf
  v_add_f32_dpp v41, v51, v41 quad_perm:[3,3,3,3] row_mask:0xf bank_mask:0xf
  v_cndmask_b32 v56, v56, v41, s[52:53]
  v_mfma_f32_16x16x32_bf16 v[44:47], v[72:75], v[24:27], 0
  v_mfma_f32_16x16x32_bf16 v[48:51], v[200:203], v[24:27], 0
  v_xor_b32 v3, s28, v18
  s_waitcnt vmcnt(4)
  buffer_load_dwordx4 v[72:75], v3, s[20:23], 0 offen nt
  s_nop 3
  v_mov_b32_dpp v41, v44 quad_perm:[0,0,0,0] row_mask:0xf bank_mask:0xf
  v_add_f32_dpp v41, v45, v41 quad_perm:[1,1,1,1] row_mask:0xf bank_mask:0xf
  v_add_f32_dpp v41, v46, v41 quad_perm:[2,2,2,2] row_mask:0xf bank_mask:0xf
  v_add_f32_dpp v41, v47, v41 quad_perm:[3,3,3,3] row_mask:0xf bank_mask:0xf
  v_cndmask_b32 v52, v52, v41, s[54:55]
  v_mov_b32_dpp v41, v48 quad_perm:[0,0,0,0] row_mask:0xf bank_mask:0xf
  v_add_f32_dpp v41, v49, v41 quad_perm:[1,1,1,1] row_mask:0xf bank_mask:0xf
  v_add_f32_dpp v41, v50, v41 quad_perm:[2,2,2,2] row_mask:0xf bank_mask:0xf
  v_add_f32_dpp v41, v51, v41 quad_perm:[3,3,3,3] row_mask:0xf bank_mask:0xf
  v_cndmask_b32 v56, v56, v41, s[54:55]
  v_mfma_f32_16x16x32_bf16 v[44:47], v[76:79], v[24:27], 0
  v_mfma_f32_16x16x32_bf16 v[48:51], v[204:207], v[24:27], 0
  v_xor_b32 v3, s28, v19
  s_waitcnt vmcnt(4)
  buffer_load_dwordx4 v[76:79], v3, s[20:23], 0 offen nt
  s_nop 3
  v_mov_b32_dpp v41, v44 quad_perm:[0,0,0,0] row_mask:0xf bank_mask:0xf
  v_add_f32_dpp v41, v45, v41 quad_perm:[1,1,1,1] row_mask:0xf bank_mask:0xf
  v_add_f32_dpp v41, v46, v41 quad_perm:[2,2,2,2] row_mask:0xf bank_mask:0xf
  v_add_f32_dpp v41, v47, v41 quad_perm:[3,3,3,3] row_mask:0xf bank_mask:0xf
  v_cndmask_b32 v52, v52, v41, s[56:57]
  v_mov_b32_dpp v41, v48 quad_perm:[0,0,0,0] row_mask:0xf bank_mask:0xf
  v_add_f32_dpp v41, v49, v41 quad_perm:[1,1,1,1] row_mask:0xf bank_mask:0xf
  v_add_f32_dpp v41, v50, v41 quad_perm:[2,2,2,2] row_mask:0xf bank_mask:0xf
  v_add_f32_dpp v41, v51, v41 quad_perm:[3,3,3,3] row_mask:0xf bank_mask:0xf
  v_cndmask_b32 v56, v56, v41, s[56:57]
  v_readlane_b32 s28, v20, s32
  s_add_u32 s32, s32, 1
  v_mfma_f32_16x16x32_bf16 v[44:47], v[80:83], v[24:27], 0
  v_mfma_f32_16x16x32_bf16 v[48:51], v[208:211], v[24:27], 0
  v_xor_b32 v3, s28, v16
  s_waitcnt vmcnt(4)
  buffer_load_dwordx4 v[80:83], v3, s[20:23], 0 offen nt
  s_nop 3
  v_mov_b32_dpp v41, v44 quad_perm:[0,0,0,0] row_mask:0xf bank_mask:0xf
  v_add_f32_dpp v41, v45, v41 quad_perm:[1,1,1,1] row_mask:0xf bank_mask:0xf
  v_add_f32_dpp v41, v46, v41 quad_perm:[2,2,2,2] row_mask:0xf bank_mask:0xf
  v_add_f32_dpp v53, v47, v41 quad_perm:[3,3,3,3] row_mask:0xf bank_mask:0xf
  v_mov_b32_dpp v41, v48 quad_perm:[0,0,0,0] row_mask:0xf bank_mask:0xf
  v_add_f32_dpp v41, v49, v41 quad_perm:[1,1,1,1] row_mask:0xf bank_mask:0xf
  v_add_f32_dpp v41, v50, v41 quad_perm:[2,2,2,2] row_mask:0xf bank_mask:0xf
  v_add_f32_dpp v57, v51, v41 quad_perm:[3,3,3,3] row_mask:0xf bank_mask:0xf
  v_mfma_f32_16x16x32_bf16 v[44:47], v[84:87], v[24:27], 0
  v_mfma_f32_16x16x32_bf16 v[48:51], v[212:215], v[24:27], 0
  v_xor_b32 v3, s28, v17
  s_waitcnt vmcnt(4)
  buffer_load_dwordx4 v[84:87], v3, s[20:23], 0 offen nt
  s_nop 3
  v_mov_b32_dpp v41, v44 quad_perm:[0,0,0,0] row_mask:0xf bank_mask:0xf
  v_add_f32_dpp v41, v45, v41 quad_perm:[1,1,1,1] row_mask:0xf bank_mask:0xf
  v_add_f32_dpp v41, v46, v41 quad_perm:[2,2,2,2] row_mask:0xf bank_mask:0xf
  v_add_f32_dpp v41, v47, v41 quad_perm:[3,3,3,3] row_mask:0xf bank_mask:0xf
  v_cndmask_b32 v53, v53, v41, s[52:53]
  v_mov_b32_dpp v41, v48 quad_perm:[0,0,0,0] row_mask:0xf bank_mask:0xf
  v_add_f32_dpp v41, v49, v41 quad_perm:[1,1,1,1] row_mask:0xf bank_mask:0xf
  v_add_f32_dpp v41, v50, v41 quad_perm:[2,2,2,2] row_mask:0xf bank_mask:0xf
  v_add_f32_dpp v41, v51, v41 quad_perm:[3,3,3,3] row_mask:0xf bank_mask:0xf
  v_cndmask_b32 v57, v57, v41, s[52:53]
  v_mfma_f32_16x16x32_bf16 v[44:47], v[88:91], v[24:27], 0
  v_mfma_f32_16x16x32_bf16 v[48:51], v[216:219], v[24:27], 0
  v_xor_b32 v3, s28, v18
  s_waitcnt vmcnt(4)
  buffer_load_dwordx4 v[88:91], v3, s[20:23], 0 offen nt
  s_nop 3
  v_mov_b32_dpp v41, v44 quad_perm:[0,0,0,0] row_mask:0xf bank_mask:0xf
  v_add_f32_dpp v41, v45, v41 quad_perm:[1,1,1,1] row_mask:0xf bank_mask:0xf
  v_add_f32_dpp v41, v46, v41 quad_perm:[2,2,2,2] row_mask:0xf bank_mask:0xf
  v_add_f32_dpp v41, v47, v41 quad_perm:[3,3,3,3] row_mask:0xf bank_mask:0xf
  v_cndmask_b32 v53, v53, v41, s[54:55]
  v_mov_b32_dpp v41, v48 quad_perm:[0,0,0,0] row_mask:0xf bank_mask:0xf
  v_add_f32_dpp v41, v49, v41 quad_perm:[1,1,1,1] row_mask:0xf bank_mask:0xf
  v_add_f32_dpp v41, v50, v41 quad_perm:[2,2,2,2] row_mask:0xf bank_mask:0xf
  v_add_f32_dpp v41, v51, v41 quad_perm:[3,3,3,3] row_mask:0xf bank_mask:0xf
  v_cndmask_b32 v57, v57, v41, s[54:55]
  v_mfma_f32_16x16x32_bf16 v[44:47], v[92:95], v[24:27], 0
  v_mfma_f32_16x16x32_bf16 v[48:51], v[220:223], v[24:27], 0
  v_xor_b32 v3, s28, v19
  s_waitcnt vmcnt(4)
  buffer_load_dwordx4 v[92:95], v3, s[20:23], 0 offen nt
  s_nop 3
  v_mov_b32_dpp v41, v44 quad_perm:[0,0,0,0] row_mask:0xf bank_mask:0xf
  v_add_f32_dpp v41, v45, v41 quad_perm:[1,1,1,1] row_mask:0xf bank_mask:0xf
  v_add_f32_dpp v41, v46, v41 quad_perm:[2,2,2,2] row_mask:0xf bank_mask:0xf
  v_add_f32_dpp v41, v47, v41 quad_perm:[3,3,3,3] row_mask:0xf bank_mask:0xf
  v_cndmask_b32 v53, v53, v41, s[56:57]
  v_mov_b32_dpp v41, v48 quad_perm:[0,0,0,0] row_mask:0xf bank_mask:0xf
  v_add_f32_dpp v41, v49, v41 quad_perm:[1,1,1,1] row_mask:0xf bank_mask:0xf
  v_add_f32_dpp v41, v50, v41 quad_perm:[2,2,2,2] row_mask:0xf bank_mask:0xf
  v_add_f32_dpp v41, v51, v41 quad_perm:[3,3,3,3] row_mask:0xf bank_mask:0xf
  v_cndmask_b32 v57, v57, v41, s[56:57]
  v_readlane_b32 s28, v20, s32
  s_add_u32 s32, s32, 1
  v_mfma_f32_16x16x32_bf16 v[44:47], v[96:99], v[24:27], 0
  v_mfma_f32_16x16x32_bf16 v[48:51], v[224:227], v[24:27], 0
  v_xor_b32 v3, s28, v16
  s_waitcnt vmcnt(4)
  buffer_load_dwordx4 v[96:99], v3, s[20:23], 0 offen nt
  s_nop 3
  v_mov_b32_dpp v41, v44 quad_perm:[0,0,0,0] row_mask:0xf bank_mask:0xf
  v_add_f32_dpp v41, v45, v41 quad_perm:[1,1,1,1] row_mask:0xf bank_mask:0xf
  v_add_f32_dpp v41, v46, v41 quad_perm:[2,2,2,2] row_mask:0xf bank_mask:0xf
  v_add_f32_dpp v54, v47, v41 quad_perm:[3,3,3,3] row_mask:0xf bank_mask:0xf
  v_mov_b32_dpp v41, v48 quad_perm:[0,0,0,0] row_mask:0xf bank_mask:0xf
  v_add_f32_dpp v41, v49, v41 quad_perm:[1,1,1,1] row_mask:0xf bank_mask:0xf
  v_add_f32_dpp v41, v50, v41 quad_perm:[2,2,2,2] row_mask:0xf bank_mask:0xf
  v_add_f32_dpp v58, v51, v41 quad_perm:[3,3,3,3] row_mask:0xf bank_mask:0xf
  v_mfma_f32_16x16x32_bf16 v[44:47], v[100:103], v[24:27], 0
  v_mfma_f32_16x16x32_bf16 v[48:51], v[228:231], v[24:27], 0
  v_xor_b32 v3, s28, v17
  s_waitcnt vmcnt(4)
  buffer_load_dwordx4 v[100:103], v3, s[20:23], 0 offen nt
  s_nop 3
  v_mov_b32_dpp v41, v44 quad_perm:[0,0,0,0] row_mask:0xf bank_mask:0xf
  v_add_f32_dpp v41, v45, v41 quad_perm:[1,1,1,1] row_mask:0xf bank_mask:0xf
  v_add_f32_dpp v41, v46, v41 quad_perm:[2,2,2,2] row_mask:0xf bank_mask:0xf
  v_add_f32_dpp v41, v47, v41 quad_perm:[3,3,3,3] row_mask:0xf bank_mask:0xf
  v_cndmask_b32 v54, v54, v41, s[52:53]
  v_mov_b32_dpp v41, v48 quad_perm:[0,0,0,0] row_mask:0xf bank_mask:0xf
  v_add_f32_dpp v41, v49, v41 quad_perm:[1,1,1,1] row_mask:0xf bank_mask:0xf
  v_add_f32_dpp v41, v50, v41 quad_perm:[2,2,2,2] row_mask:0xf bank_mask:0xf
  v_add_f32_dpp v41, v51, v41 quad_perm:[3,3,3,3] row_mask:0xf bank_mask:0xf
  v_cndmask_b32 v58, v58, v41, s[52:53]
  v_mfma_f32_16x16x32_bf16 v[44:47], v[104:107], v[24:27], 0
  v_mfma_f32_16x16x32_bf16 v[48:51], v[232:235], v[24:27], 0
  v_xor_b32 v3, s28, v18
  s_waitcnt vmcnt(4)
  buffer_load_dwordx4 v[104:107], v3, s[20:23], 0 offen nt
  s_nop 3
  v_mov_b32_dpp v41, v44 quad_perm:[0,0,0,0] row_mask:0xf bank_mask:0xf
  v_add_f32_dpp v41, v45, v41 quad_perm:[1,1,1,1] row_mask:0xf bank_mask:0xf
  v_add_f32_dpp v41, v46, v41 quad_perm:[2,2,2,2] row_mask:0xf bank_mask:0xf
  v_add_f32_dpp v41, v47, v41 quad_perm:[3,3,3,3] row_mask:0xf bank_mask:0xf
  v_cndmask_b32 v54, v54, v41, s[54:55]
  v_mov_b32_dpp v41, v48 quad_perm:[0,0,0,0] row_mask:0xf bank_mask:0xf
  v_add_f32_dpp v41, v49, v41 quad_perm:[1,1,1,1] row_mask:0xf bank_mask:0xf
  v_add_f32_dpp v41, v50, v41 quad_perm:[2,2,2,2] row_mask:0xf bank_mask:0xf
  v_add_f32_dpp v41, v51, v41 quad_perm:[3,3,3,3] row_mask:0xf bank_mask:0xf
  v_cndmask_b32 v58, v58, v41, s[54:55]
  v_mfma_f32_16x16x32_bf16 v[44:47], v[108:111], v[24:27], 0
  v_mfma_f32_16x16x32_bf16 v[48:51], v[236:239], v[24:27], 0
  v_xor_b32 v3, s28, v19
  s_waitcnt vmcnt(4)
  buffer_load_dwordx4 v[108:111], v3, s[20:23], 0 offen nt
  s_nop 3
  v_mov_b32_dpp v41, v44 quad_perm:[0,0,0,0] row_mask:0xf bank_mask:0xf
  v_add_f32_dpp v41, v45, v41 quad_perm:[1,1,1,1] row_mask:0xf bank_mask:0xf
  v_add_f32_dpp v41, v46, v41 quad_perm:[2,2,2,2] row_mask:0xf bank_mask:0xf
  v_add_f32_dpp v41, v47, v41 quad_perm:[3,3,3,3] row_mask:0xf bank_mask:0xf
  v_cndmask_b32 v54, v54, v41, s[56:57]
  v_mov_b32_dpp v41, v48 quad_perm:[0,0,0,0] row_mask:0xf bank_mask:0xf
  v_add_f32_dpp v41, v49, v41 quad_perm:[1,1,1,1] row_mask:0xf bank_mask:0xf
  v_add_f32_dpp v41, v50, v41 quad_perm:[2,2,2,2] row_mask:0xf bank_mask:0xf
  v_add_f32_dpp v41, v51, v41 quad_perm:[3,3,3,3] row_mask:0xf bank_mask:0xf
  v_cndmask_b32 v58, v58, v41, s[56:57]
  v_readlane_b32 s28, v20, s32
  s_add_u32 s32, s32, 1
  v_mfma_f32_16x16x32_bf16 v[44:47], v[112:115], v[24:27], 0
  v_mfma_f32_16x16x32_bf16 v[48:51], v[240:243], v[24:27], 0
  v_xor_b32 v3, s28, v16
  s_waitcnt vmcnt(4)
  buffer_load_dwordx4 v[112:115], v3, s[20:23], 0 offen nt
  s_nop 3
  v_mov_b32_dpp v41, v44 quad_perm:[0,0,0,0] row_mask:0xf bank_mask:0xf
  v_add_f32_dpp v41, v45, v41 quad_perm:[1,1,1,1] row_mask:0xf bank_mask:0xf
  v_add_f32_dpp v41, v46, v41 quad_perm:[2,2,2,2] row_mask:0xf bank_mask:0xf
  v_add_f32_dpp v55, v47, v41 quad_perm:[3,3,3,3] row_mask:0xf bank_mask:0xf
  v_mov_b32_dpp v41, v48 quad_perm:[0,0,0,0] row_mask:0xf bank_mask:0xf
  v_add_f32_dpp v41, v49, v41 quad_perm:[1,1,1,1] row_mask:0xf bank_mask:0xf
  v_add_f32_dpp v41, v50, v41 quad_perm:[2,2,2,2] row_mask:0xf bank_mask:0xf
  v_add_f32_dpp v59, v51, v41 quad_perm:[3,3,3,3] row_mask:0xf bank_mask:0xf
  v_mfma_f32_16x16x32_bf16 v[44:47], v[116:119], v[24:27], 0
  v_mfma_f32_16x16x32_bf16 v[48:51], v[244:247], v[24:27], 0
  v_xor_b32 v3, s28, v17
  s_waitcnt vmcnt(4)
  buffer_load_dwordx4 v[116:119], v3, s[20:23], 0 offen nt
  s_nop 3
  v_mov_b32_dpp v41, v44 quad_perm:[0,0,0,0] row_mask:0xf bank_mask:0xf
  v_add_f32_dpp v41, v45, v41 quad_perm:[1,1,1,1] row_mask:0xf bank_mask:0xf
  v_add_f32_dpp v41, v46, v41 quad_perm:[2,2,2,2] row_mask:0xf bank_mask:0xf
  v_add_f32_dpp v41, v47, v41 quad_perm:[3,3,3,3] row_mask:0xf bank_mask:0xf
  v_cndmask_b32 v55, v55, v41, s[52:53]
  v_mov_b32_dpp v41, v48 quad_perm:[0,0,0,0] row_mask:0xf bank_mask:0xf
  v_add_f32_dpp v41, v49, v41 quad_perm:[1,1,1,1] row_mask:0xf bank_mask:0xf
  v_add_f32_dpp v41, v50, v41 quad_perm:[2,2,2,2] row_mask:0xf bank_mask:0xf
  v_add_f32_dpp v41, v51, v41 quad_perm:[3,3,3,3] row_mask:0xf bank_mask:0xf
  v_cndmask_b32 v59, v59, v41, s[52:53]
  v_mfma_f32_16x16x32_bf16 v[44:47], v[120:123], v[24:27], 0
  v_mfma_f32_16x16x32_bf16 v[48:51], v[248:251], v[24:27], 0
  v_xor_b32 v3, s28, v18
  s_waitcnt vmcnt(4)
  buffer_load_dwordx4 v[120:123], v3, s[20:23], 0 offen nt
  s_nop 3
  v_mov_b32_dpp v41, v44 quad_perm:[0,0,0,0] row_mask:0xf bank_mask:0xf
  v_add_f32_dpp v41, v45, v41 quad_perm:[1,1,1,1] row_mask:0xf bank_mask:0xf
  v_add_f32_dpp v41, v46, v41 quad_perm:[2,2,2,2] row_mask:0xf bank_mask:0xf
  v_add_f32_dpp v41, v47, v41 quad_perm:[3,3,3,3] row_mask:0xf bank_mask:0xf
  v_cndmask_b32 v55, v55, v41, s[54:55]
  v_mov_b32_dpp v41, v48 quad_perm:[0,0,0,0] row_mask:0xf bank_mask:0xf
  v_add_f32_dpp v41, v49, v41 quad_perm:[1,1,1,1] row_mask:0xf bank_mask:0xf
  v_add_f32_dpp v41, v50, v41 quad_perm:[2,2,2,2] row_mask:0xf bank_mask:0xf
  v_add_f32_dpp v41, v51, v41 quad_perm:[3,3,3,3] row_mask:0xf bank_mask:0xf
  v_cndmask_b32 v59, v59, v41, s[54:55]
  v_mfma_f32_16x16x32_bf16 v[44:47], v[124:127], v[24:27], 0
  v_mfma_f32_16x16x32_bf16 v[48:51], v[252:255], v[24:27], 0
  v_xor_b32 v3, s28, v19
  s_waitcnt vmcnt(4)
  buffer_load_dwordx4 v[124:127], v3, s[20:23], 0 offen nt
  s_nop 3
  v_mov_b32_dpp v41, v44 quad_perm:[0,0,0,0] row_mask:0xf bank_mask:0xf
  v_add_f32_dpp v41, v45, v41 quad_perm:[1,1,1,1] row_mask:0xf bank_mask:0xf
  v_add_f32_dpp v41, v46, v41 quad_perm:[2,2,2,2] row_mask:0xf bank_mask:0xf
  v_add_f32_dpp v41, v47, v41 quad_perm:[3,3,3,3] row_mask:0xf bank_mask:0xf
  v_cndmask_b32 v55, v55, v41, s[56:57]
  v_mov_b32_dpp v41, v48 quad_perm:[0,0,0,0] row_mask:0xf bank_mask:0xf
  v_add_f32_dpp v41, v49, v41 quad_perm:[1,1,1,1] row_mask:0xf bank_mask:0xf
  v_add_f32_dpp v41, v50, v41 quad_perm:[2,2,2,2] row_mask:0xf bank_mask:0xf
  v_add_f32_dpp v41, v51, v41 quad_perm:[3,3,3,3] row_mask:0xf bank_mask:0xf
  v_cndmask_b32 v59, v59, v41, s[56:57]
  v_max3_f32 v36, v36, v52, v53
  v_max3_f32 v36, v36, v54, v55
  ds_write_b128 v42, v[52:55] offset:23552
  v_max3_f32 v36, v36, v56, v57
  v_max3_f32 v36, v36, v58, v59
  ds_write_b128 v42, v[56:59] offset:22528
  v_add_u32 v42, 4096, v42
  s_mov_b32 s36, 4
L_K:
  s_cmp_lg_u32 s36, 1
  s_cbranch_scc1 L_Kgo
  s_mov_b32 s20, s14
  s_mov_b32 s21, s15
  s_mov_b32 s32, 0
  v_mov_b32 v16, v12
  v_mov_b32 v17, v13
  v_mov_b32 v18, v14
  v_mov_b32 v19, v15
L_Kgo:
  v_readlane_b32 s28, v20, s32
  s_add_u32 s32, s32, 1
  v_mfma_f32_16x16x32_bf16 v[44:47], v[64:67], v[24:27], 0
  v_xor_b32 v3, s28, v16
  s_waitcnt vmcnt(4)
  buffer_load_dwordx4 v[64:67], v3, s[20:23], 0 offen nt
  s_nop 4
  v_mov_b32_dpp v41, v44 quad_perm:[0,0,0,0] row_mask:0xf bank_mask:0xf
  v_add_f32_dpp v41, v45, v41 quad_perm:[1,1,1,1] row_mask:0xf bank_mask:0xf
  v_add_f32_dpp v41, v46, v41 quad_perm:[2,2,2,2] row_mask:0xf bank_mask:0xf
  v_add_f32_dpp v52, v47, v41 quad_perm:[3,3,3,3] row_mask:0xf bank_mask:0xf
  v_mfma_f32_16x16x32_bf16 v[44:47], v[68:71], v[24:27], 0
  v_xor_b32 v3, s28, v17
  s_waitcnt vmcnt(4)
  buffer_load_dwordx4 v[68:71], v3, s[20:23], 0 offen nt
  s_nop 4
  v_mov_b32_dpp v41, v44 quad_perm:[0,0,0,0] row_mask:0xf bank_mask:0xf
  v_add_f32_dpp v41, v45, v41 quad_perm:[1,1,1,1] row_mask:0xf bank_mask:0xf
  v_add_f32_dpp v41, v46, v41 quad_perm:[2,2,2,2] row_mask:0xf bank_mask:0xf
  v_add_f32_dpp v41, v47, v41 quad_perm:[3,3,3,3] row_mask:0xf bank_mask:0xf
  v_cndmask_b32 v52, v52, v41, s[52:53]
  v_mfma_f32_16x16x32_bf16 v[44:47], v[72:75], v[24:27], 0
  v_xor_b32 v3, s28, v18
  s_waitcnt vmcnt(4)
  buffer_load_dwordx4 v[72:75], v3, s[20:23], 0 offen nt
  s_nop 4
  v_mov_b32_dpp v41, v44 quad_perm:[0,0,0,0] row_mask:0xf bank_mask:0xf
  v_add_f32_dpp v41, v45, v41 quad_perm:[1,1,1,1] row_mask:0xf bank_mask:0xf
  v_add_f32_dpp v41, v46, v41 quad_perm:[2,2,2,2] row_mask:0xf bank_mask:0xf
  v_add_f32_dpp v41, v47, v41 quad_perm:[3,3,3,3] row_mask:0xf bank_mask:0xf
  v_cndmask_b32 v52, v52, v41, s[54:55]
  v_mfma_f32_16x16x32_bf16 v[44:47], v[76:79], v[24:27], 0
  v_xor_b32 v3, s28, v19
  s_waitcnt vmcnt(4)
  buffer_load_dwordx4 v[76:79], v3, s[20:23], 0 offen nt
  s_nop 4
  v_mov_b32_dpp v41, v44 quad_perm:[0,0,0,0] row_mask:0xf bank_mask:0xf
  v_add_f32_dpp v41, v45, v41 quad_perm:[1,1,1,1] row_mask:0xf bank_mask:0xf
  v_add_f32_dpp v41, v46, v41 quad_perm:[2,2,2,2] row_mask:0xf bank_mask:0xf
  v_add_f32_dpp v41, v47, v41 quad_perm:[3,3,3,3] row_mask:0xf bank_mask:0xf
  v_cndmask_b32 v52, v52, v41, s[56:57]
  v_readlane_b32 s28, v20, s32
  s_add_u32 s32, s32, 1
  v_mfma_f32_16x16x32_bf16 v[44:47], v[80:83], v[24:27], 0
  v_xor_b32 v3, s28, v16
  s_waitcnt vmcnt(4)
  buffer_load_dwordx4 v[80:83], v3, s[20:23], 0 offen nt
  s_nop 4
  v_mov_b32_dpp v41, v44 quad_perm:[0,0,0,0] row_mask:0xf bank_mask:0xf
  v_add_f32_dpp v41, v45, v41 quad_perm:[1,1,1,1] row_mask:0xf bank_mask:0xf
  v_add_f32_dpp v41, v46, v41 quad_perm:[2,2,2,2] row_mask:0xf bank_mask:0xf
  v_add_f32_dpp v53, v47, v41 quad_perm:[3,3,3,3] row_mask:0xf bank_mask:0xf
  v_mfma_f32_16x16x32_bf16 v[44:47], v[84:87], v[24:27], 0
  v_xor_b32 v3, s28, v17
  s_waitcnt vmcnt(4)
  buffer_load_dwordx4 v[84:87], v3, s[20:23], 0 offen nt
  s_nop 4
  v_mov_b32_dpp v41, v44 quad_perm:[0,0,0,0] row_mask:0xf bank_mask:0xf
  v_add_f32_dpp v41, v45, v41 quad_perm:[1,1,1,1] row_mask:0xf bank_mask:0xf
  v_add_f32_dpp v41, v46, v41 quad_perm:[2,2,2,2] row_mask:0xf bank_mask:0xf
  v_add_f32_dpp v41, v47, v41 quad_perm:[3,3,3,3] row_mask:0xf bank_mask:0xf
  v_cndmask_b32 v53, v53, v41, s[52:53]
  v_mfma_f32_16x16x32_bf16 v[44:47], v[88:91], v[24:27], 0
  v_xor_b32 v3, s28, v18
  s_waitcnt vmcnt(4)
  buffer_load_dwordx4 v[88:91], v3, s[20:23], 0 offen nt
  s_nop 4
  v_mov_b32_dpp v41, v44 quad_perm:[0,0,0,0] row_mask:0xf bank_mask:0xf
  v_add_f32_dpp v41, v45, v41 quad_perm:[1,1,1,1] row_mask:0xf bank_mask:0xf
  v_add_f32_dpp v41, v46, v41 quad_perm:[2,2,2,2] row_mask:0xf bank_mask:0xf
  v_add_f32_dpp v41, v47, v41 quad_perm:[3,3,3,3] row_mask:0xf bank_mask:0xf
  v_cndmask_b32 v53, v53, v41, s[54:55]
  v_mfma_f32_16x16x32_bf16 v[44:47], v[92:95], v[24:27], 0
  v_xor_b32 v3, s28, v19
  s_waitcnt vmcnt(4)
  buffer_load_dwordx4 v[92:95], v3, s[20:23], 0 offen nt
  s_nop 4
  v_mov_b32_dpp v41, v44 quad_perm:[0,0,0,0] row_mask:0xf bank_mask:0xf
  v_add_f32_dpp v41, v45, v41 quad_perm:[1,1,1,1] row_mask:0xf bank_mask:0xf
  v_add_f32_dpp v41, v46, v41 quad_perm:[2,2,2,2] row_mask:0xf bank_mask:0xf
  v_add_f32_dpp v41, v47, v41 quad_perm:[3,3,3,3] row_mask:0xf bank_mask:0xf
  v_cndmask_b32 v53, v53, v41, s[56:57]
  v_readlane_b32 s28, v20, s32
  s_add_u32 s32, s32, 1
  v_mfma_f32_16x16x32_bf16 v[44:47], v[96:99], v[24:27], 0
  v_xor_b32 v3, s28, v16
  s_waitcnt vmcnt(4)
  buffer_load_dwordx4 v[96:99], v3, s[20:23], 0 offen nt
  s_nop 4
  v_mov_b32_dpp v41, v44 quad_perm:[0,0,0,0] row_mask:0xf bank_mask:0xf
  v_add_f32_dpp v41, v45, v41 quad_perm:[1,1,1,1] row_mask:0xf bank_mask:0xf
  v_add_f32_dpp v41, v46, v41 quad_perm:[2,2,2,2] row_mask:0xf bank_mask:0xf
  v_add_f32_dpp v54, v47, v41 quad_perm:[3,3,3,3] row_mask:0xf bank_mask:0xf
  v_mfma_f32_16x16x32_bf16 v[44:47], v[100:103], v[24:27], 0
  v_xor_b32 v3, s28, v17
  s_waitcnt vmcnt(4)
  buffer_load_dwordx4 v[100:103], v3, s[20:23], 0 offen nt
  s_nop 4
  v_mov_b32_dpp v41, v44 quad_perm:[0,0,0,0] row_mask:0xf bank_mask:0xf
  v_add_f32_dpp v41, v45, v41 quad_perm:[1,1,1,1] row_mask:0xf bank_mask:0xf
  v_add_f32_dpp v41, v46, v41 quad_perm:[2,2,2,2] row_mask:0xf bank_mask:0xf
  v_add_f32_dpp v41, v47, v41 quad_perm:[3,3,3,3] row_mask:0xf bank_mask:0xf
  v_cndmask_b32 v54, v54, v41, s[52:53]
  v_mfma_f32_16x16x32_bf16 v[44:47], v[104:107], v[24:27], 0
  v_xor_b32 v3, s28, v18
  s_waitcnt vmcnt(4)
  buffer_load_dwordx4 v[104:107], v3, s[20:23], 0 offen nt
  s_nop 4
  v_mov_b32_dpp v41, v44 quad_perm:[0,0,0,0] row_mask:0xf bank_mask:0xf
  v_add_f32_dpp v41, v45, v41 quad_perm:[1,1,1,1] row_mask:0xf bank_mask:0xf
  v_add_f32_dpp v41, v46, v41 quad_perm:[2,2,2,2] row_mask:0xf bank_mask:0xf
  v_add_f32_dpp v41, v47, v41 quad_perm:[3,3,3,3] row_mask:0xf bank_mask:0xf
  v_cndmask_b32 v54, v54, v41, s[54:55]
  v_mfma_f32_16x16x32_bf16 v[44:47], v[108:111], v[24:27], 0
  v_xor_b32 v3, s28, v19
  s_waitcnt vmcnt(4)
  buffer_load_dwordx4 v[108:111], v3, s[20:23], 0 offen nt
  s_nop 4
  v_mov_b32_dpp v41, v44 quad_perm:[0,0,0,0] row_mask:0xf bank_mask:0xf
  v_add_f32_dpp v41, v45, v41 quad_perm:[1,1,1,1] row_mask:0xf bank_mask:0xf
  v_add_f32_dpp v41, v46, v41 quad_perm:[2,2,2,2] row_mask:0xf bank_mask:0xf
  v_add_f32_dpp v41, v47, v41 quad_perm:[3,3,3,3] row_mask:0xf bank_mask:0xf
  v_cndmask_b32 v54, v54, v41, s[56:57]
  v_readlane_b32 s28, v20, s32
  s_add_u32 s32, s32, 1
  v_mfma_f32_16x16x32_bf16 v[44:47], v[112:115], v[24:27], 0
  v_xor_b32 v3, s28, v16
  s_waitcnt vmcnt(4)
  buffer_load_dwordx4 v[112:115], v3, s[20:23], 0 offen nt
  s_nop 4
  v_mov_b32_dpp v41, v44 quad_perm:[0,0,0,0] row_mask:0xf bank_mask:0xf
  v_add_f32_dpp v41, v45, v41 quad_perm:[1,1,1,1] row_mask:0xf bank_mask:0xf
  v_add_f32_dpp v41, v46, v41 quad_perm:[2,2,2,2] row_mask:0xf bank_mask:0xf
  v_add_f32_dpp v55, v47, v41 quad_perm:[3,3,3,3] row_mask:0xf bank_mask:0xf
  v_mfma_f32_16x16x32_bf16 v[44:47], v[116:119], v[24:27], 0
  v_xor_b32 v3, s28, v17
  s_waitcnt vmcnt(4)
  buffer_load_dwordx4 v[116:119], v3, s[20:23], 0 offen nt
  s_nop 4
  v_mov_b32_dpp v41, v44 quad_perm:[0,0,0,0] row_mask:0xf bank_mask:0xf
  v_add_f32_dpp v41, v45, v41 quad_perm:[1,1,1,1] row_mask:0xf bank_mask:0xf
  v_add_f32_dpp v41, v46, v41 quad_perm:[2,2,2,2] row_mask:0xf bank_mask:0xf
  v_add_f32_dpp v41, v47, v41 quad_perm:[3,3,3,3] row_mask:0xf bank_mask:0xf
  v_cndmask_b32 v55, v55, v41, s[52:53]
  v_mfma_f32_16x16x32_bf16 v[44:47], v[120:123], v[24:27], 0
  v_xor_b32 v3, s28, v18
  s_waitcnt vmcnt(4)
  buffer_load_dwordx4 v[120:123], v3, s[20:23], 0 offen nt
  s_nop 4
  v_mov_b32_dpp v41, v44 quad_perm:[0,0,0,0] row_mask:0xf bank_mask:0xf
  v_add_f32_dpp v41, v45, v41 quad_perm:[1,1,1,1] row_mask:0xf bank_mask:0xf
  v_add_f32_dpp v41, v46, v41 quad_perm:[2,2,2,2] row_mask:0xf bank_mask:0xf
  v_add_f32_dpp v41, v47, v41 quad_perm:[3,3,3,3] row_mask:0xf bank_mask:0xf
  v_cndmask_b32 v55, v55, v41, s[54:55]
  v_mfma_f32_16x16x32_bf16 v[44:47], v[124:127], v[24:27], 0
  v_xor_b32 v3, s28, v19
  s_waitcnt vmcnt(4)
  buffer_load_dwordx4 v[124:127], v3, s[20:23], 0 offen nt
  s_nop 4
  v_mov_b32_dpp v41, v44 quad_perm:[0,0,0,0] row_mask:0xf bank_mask:0xf
  v_add_f32_dpp v41, v45, v41 quad_perm:[1,1,1,1] row_mask:0xf bank_mask:0xf
  v_add_f32_dpp v41, v46, v41 quad_perm:[2,2,2,2] row_mask:0xf bank_mask:0xf
  v_add_f32_dpp v41, v47, v41 quad_perm:[3,3,3,3] row_mask:0xf bank_mask:0xf
  v_cndmask_b32 v55, v55, v41, s[56:57]
  v_max3_f32 v36, v36, v52, v53
  v_max3_f32 v36, v36, v54, v55
  ds_write_b128 v42, v[52:55] offset:20480
  v_add_u32 v42, 1024, v42
  s_sub_u32 s36, s36, 1
  s_cmp_lg_u32 s36, 0
  s_cbranch_scc1 L_K
  v_lshlrev_b32 v42, 4, v2
  s_lshl_b32 s30, s7, 13
  v_add_u32 v42, s30, v42
  ds_read_b128 v[52:55], v42 offset:20480
  v_max_f32_dpp v36, v36, v36 quad_perm:[1,0,3,2] row_mask:0xf bank_mask:0xf
  s_nop 1
  v_max_f32_dpp v36, v36, v36 quad_perm:[2,3,0,1] row_mask:0xf bank_mask:0xf
  v_mov_b32 v39, v36
  s_nop 1
  v_permlane16_swap_b32 v39, v36
  v_max_f32 v36, v36, v39
  v_mov_b32 v39, v36
  s_nop 1
  v_permlane32_swap_b32 v39, v36
  v_max_f32 v36, v36, v39
  v_mul_f32 v37, s37, v36
  s_cmp_eq_u32 s42, 0
  s_cselect_b32 s36, 8, 6
  s_cselect_b32 s43, 1, 0
L_V:
  s_cmp_lg_u32 s36, s43
  s_cbranch_scc1 L_Vgo
  s_mov_b32 s20, s16
  s_mov_b32 s21, s17
  s_mov_b32 s32, 0
  v_mov_b32 v16, v8
  v_mov_b32 v17, v9
  v_mov_b32 v18, v10
  v_mov_b32 v19, v11
L_Vgo:
  s_waitcnt lgkmcnt(0)
  v_fma_f32 v60, v52, s37, -v37
  v_fma_f32 v61, v53, s37, -v37
  v_fma_f32 v62, v54, s37, -v37
  v_fma_f32 v63, v55, s37, -v37
  v_exp_f32 v60, v60
  v_exp_f32 v61, v61
  v_exp_f32 v62, v62
  v_exp_f32 v63, v63
  v_add_f32 v38, v38, v60
  v_add_f32 v38, v38, v61
  v_add_f32 v38, v38, v62
  v_add_f32 v38, v38, v63
  v_cvt_pk_bf16_f32 v60, v60, v60
  v_cvt_pk_bf16_f32 v61, v61, v61
  v_cvt_pk_bf16_f32 v62, v62, v62
  v_cvt_pk_bf16_f32 v63, v63, v63
  ds_read_b128 v[52:55], v42 offset:21504
  v_add_u32 v42, 1024, v42
  v_readlane_b32 s28, v20, s32
  s_add_u32 s32, s32, 1
  v_and_b32_dpp v22, v60, v5 quad_perm:[0,0,0,0] row_mask:0xf bank_mask:0xf
  v_and_b32_dpp v23, v60, v6 quad_perm:[0,0,0,0] row_mask:0xf bank_mask:0xf
  v_xor_b32 v3, s28, v16
  s_nop 0
  v_mfma_f32_16x16x16_bf16 v[28:31], v[22:23], v[64:65], v[28:31]
  v_mfma_f32_16x16x16_bf16 v[32:35], v[22:23], v[66:67], v[32:35]
  s_waitcnt vmcnt(4)
  buffer_load_dwordx4 v[64:67], v3, s[20:23], 0 offen nt
  v_and_b32_dpp v22, v60, v5 quad_perm:[1,1,1,1] row_mask:0xf bank_mask:0xf
  v_and_b32_dpp v23, v60, v6 quad_perm:[1,1,1,1] row_mask:0xf bank_mask:0xf
  v_xor_b32 v3, s28, v17
  s_nop 0
  v_mfma_f32_16x16x16_bf16 v[28:31], v[22:23], v[68:69], v[28:31]
  v_mfma_f32_16x16x16_bf16 v[32:35], v[22:23], v[70:71], v[32:35]
  s_waitcnt vmcnt(4)
  buffer_load_dwordx4 v[68:71], v3, s[20:23], 0 offen nt
  v_and_b32_dpp v22, v60, v5 quad_perm:[2,2,2,2] row_mask:0xf bank_mask:0xf
  v_and_b32_dpp v23, v60, v6 quad_perm:[2,2,2,2] row_mask:0xf bank_mask:0xf
  v_xor_b32 v3, s28, v18
  s_nop 0
  v_mfma_f32_16x16x16_bf16 v[28:31], v[22:23], v[72:73], v[28:31]
  v_mfma_f32_16x16x16_bf16 v[32:35], v[22:23], v[74:75], v[32:35]
  s_waitcnt vmcnt(4)
  buffer_load_dwordx4 v[72:75], v3, s[20:23], 0 offen nt
  v_and_b32_dpp v22, v60, v5 quad_perm:[3,3,3,3] row_mask:0xf bank_mask:0xf
  v_and_b32_dpp v23, v60, v6 quad_perm:[3,3,3,3] row_mask:0xf bank_mask:0xf
  v_xor_b32 v3, s28, v19
  s_nop 0
  v_mfma_f32_16x16x16_bf16 v[28:31], v[22:23], v[76:77], v[28:31]
  v_mfma_f32_16x16x16_bf16 v[32:35], v[22:23], v[78:79], v[32:35]
  s_waitcnt vmcnt(4)
  buffer_load_dwordx4 v[76:79], v3, s[20:23], 0 offen nt
  v_readlane_b32 s28, v20, s32
  s_add_u32 s32, s32, 1
  v_and_b32_dpp v22, v61, v5 quad_perm:[0,0,0,0] row_mask:0xf bank_mask:0xf
  v_and_b32_dpp v23, v61, v6 quad_perm:[0,0,0,0] row_mask:0xf bank_mask:0xf
  v_xor_b32 v3, s28, v16
  s_nop 0
  v_mfma_f32_16x16x16_bf16 v[28:31], v[22:23], v[80:81], v[28:31]
  v_mfma_f32_16x16x16_bf16 v[32:35], v[22:23], v[82:83], v[32:35]
  s_waitcnt vmcnt(4)
  buffer_load_dwordx4 v[80:83], v3, s[20:23], 0 offen nt
  v_and_b32_dpp v22, v61, v5 quad_perm:[1,1,1,1] row_mask:0xf bank_mask:0xf
  v_and_b32_dpp v23, v61, v6 quad_perm:[1,1,1,1] row_mask:0xf bank_mask:0xf
  v_xor_b32 v3, s28, v17
  s_nop 0
  v_mfma_f32_16x16x16_bf16 v[28:31], v[22:23], v[84:85], v[28:31]
  v_mfma_f32_16x16x16_bf16 v[32:35], v[22:23], v[86:87], v[32:35]
  s_waitcnt vmcnt(4)
  buffer_load_dwordx4 v[84:87], v3, s[20:23], 0 offen nt
  v_and_b32_dpp v22, v61, v5 quad_perm:[2,2,2,2] row_mask:0xf bank_mask:0xf
  v_and_b32_dpp v23, v61, v6 quad_perm:[2,2,2,2] row_mask:0xf bank_mask:0xf
  v_xor_b32 v3, s28, v18
  s_nop 0
  v_mfma_f32_16x16x16_bf16 v[28:31], v[22:23], v[88:89], v[28:31]
  v_mfma_f32_16x16x16_bf16 v[32:35], v[22:23], v[90:91], v[32:35]
  s_waitcnt vmcnt(4)
  buffer_load_dwordx4 v[88:91], v3, s[20:23], 0 offen nt
  v_and_b32_dpp v22, v61, v5 quad_perm:[3,3,3,3] row_mask:0xf bank_mask:0xf
  v_and_b32_dpp v23, v61, v6 quad_perm:[3,3,3,3] row_mask:0xf bank_mask:0xf
  v_xor_b32 v3, s28, v19
  s_nop 0
  v_mfma_f32_16x16x16_bf16 v[28:31], v[22:23], v[92:93], v[28:31]
  v_mfma_f32_16x16x16_bf16 v[32:35], v[22:23], v[94:95], v[32:35]
  s_waitcnt vmcnt(4)
  buffer_load_dwordx4 v[92:95], v3, s[20:23], 0 offen nt
  v_readlane_b32 s28, v20, s32
  s_add_u32 s32, s32, 1
  v_and_b32_dpp v22, v62, v5 quad_perm:[0,0,0,0] row_mask:0xf bank_mask:0xf
  v_and_b32_dpp v23, v62, v6 quad_perm:[0,0,0,0] row_mask:0xf bank_mask:0xf
  v_xor_b32 v3, s28, v16
  s_nop 0
  v_mfma_f32_16x16x16_bf16 v[28:31], v[22:23], v[96:97], v[28:31]
  v_mfma_f32_16x16x16_bf16 v[32:35], v[22:23], v[98:99], v[32:35]
  s_waitcnt vmcnt(4)
  buffer_load_dwordx4 v[96:99], v3, s[20:23], 0 offen nt
  v_and_b32_dpp v22, v62, v5 quad_perm:[1,1,1,1] row_mask:0xf bank_mask:0xf
  v_and_b32_dpp v23, v62, v6 quad_perm:[1,1,1,1] row_mask:0xf bank_mask:0xf
  v_xor_b32 v3, s28, v17
  s_nop 0
  v_mfma_f32_16x16x16_bf16 v[28:31], v[22:23], v[100:101], v[28:31]
  v_mfma_f32_16x16x16_bf16 v[32:35], v[22:23], v[102:103], v[32:35]
  s_waitcnt vmcnt(4)
  buffer_load_dwordx4 v[100:103], v3, s[20:23], 0 offen nt
  v_and_b32_dpp v22, v62, v5 quad_perm:[2,2,2,2] row_mask:0xf bank_mask:0xf
  v_and_b32_dpp v23, v62, v6 quad_perm:[2,2,2,2] row_mask:0xf bank_mask:0xf
  v_xor_b32 v3, s28, v18
  s_nop 0
  v_mfma_f32_16x16x16_bf16 v[28:31], v[22:23], v[104:105], v[28:31]
  v_mfma_f32_16x16x16_bf16 v[32:35], v[22:23], v[106:107], v[32:35]
  s_waitcnt vmcnt(4)
  buffer_load_dwordx4 v[104:107], v3, s[20:23], 0 offen nt
  v_and_b32_dpp v22, v62, v5 quad_perm:[3,3,3,3] row_mask:0xf bank_mask:0xf
  v_and_b32_dpp v23, v62, v6 quad_perm:[3,3,3,3] row_mask:0xf bank_mask:0xf
  v_xor_b32 v3, s28, v19
  s_nop 0
  v_mfma_f32_16x16x16_bf16 v[28:31], v[22:23], v[108:109], v[28:31]
  v_mfma_f32_16x16x16_bf16 v[32:35], v[22:23], v[110:111], v[32:35]
  s_waitcnt vmcnt(4)
  buffer_load_dwordx4 v[108:111], v3, s[20:23], 0 offen nt
  v_readlane_b32 s28, v20, s32
  s_add_u32 s32, s32, 1
  v_and_b32_dpp v22, v63, v5 quad_perm:[0,0,0,0] row_mask:0xf bank_mask:0xf
  v_and_b32_dpp v23, v63, v6 quad_perm:[0,0,0,0] row_mask:0xf bank_mask:0xf
  v_xor_b32 v3, s28, v16
  s_nop 0
  v_mfma_f32_16x16x16_bf16 v[28:31], v[22:23], v[112:113], v[28:31]
  v_mfma_f32_16x16x16_bf16 v[32:35], v[22:23], v[114:115], v[32:35]
  s_waitcnt vmcnt(4)
  buffer_load_dwordx4 v[112:115], v3, s[20:23], 0 offen nt
  v_and_b32_dpp v22, v63, v5 quad_perm:[1,1,1,1] row_mask:0xf bank_mask:0xf
  v_and_b32_dpp v23, v63, v6 quad_perm:[1,1,1,1] row_mask:0xf bank_mask:0xf
  v_xor_b32 v3, s28, v17
  s_nop 0
  v_mfma_f32_16x16x16_bf16 v[28:31], v[22:23], v[116:117], v[28:31]
  v_mfma_f32_16x16x16_bf16 v[32:35], v[22:23], v[118:119], v[32:35]
  s_waitcnt vmcnt(4)
  buffer_load_dwordx4 v[116:119], v3, s[20:23], 0 offen nt
  v_and_b32_dpp v22, v63, v5 quad_perm:[2,2,2,2] row_mask:0xf bank_mask:0xf
  v_and_b32_dpp v23, v63, v6 quad_perm:[2,2,2,2] row_mask:0xf bank_mask:0xf
  v_xor_b32 v3, s28, v18
  s_nop 0
  v_mfma_f32_16x16x16_bf16 v[28:31], v[22:23], v[120:121], v[28:31]
  v_mfma_f32_16x16x16_bf16 v[32:35], v[22:23], v[122:123], v[32:35]
  s_waitcnt vmcnt(4)
  buffer_load_dwordx4 v[120:123], v3, s[20:23], 0 offen nt
  v_and_b32_dpp v22, v63, v5 quad_perm:[3,3,3,3] row_mask:0xf bank_mask:0xf
  v_and_b32_dpp v23, v63, v6 quad_perm:[3,3,3,3] row_mask:0xf bank_mask:0xf
  v_xor_b32 v3, s28, v19
  s_nop 0
  v_mfma_f32_16x16x16_bf16 v[28:31], v[22:23], v[124:125], v[28:31]
  v_mfma_f32_16x16x16_bf16 v[32:35], v[22:23], v[126:127], v[32:35]
  s_waitcnt vmcnt(4)
  buffer_load_dwordx4 v[124:127], v3, s[20:23], 0 offen nt
  s_sub_u32 s36, s36, 1
  s_cmp_lg_u32 s36, 0
  s_cbranch_scc1 L_V
  s_cmp_lg_u32 s42, 0
  s_cbranch_scc1 L_last
  ds_read_b128 v[24:27], v1 offset:1536
  v_add_f32_dpp v38, v38, v38 quad_perm:[1,0,3,2] row_mask:0xf bank_mask:0xf
  v_lshlrev_b32 v7, 5, v0
  v_and_b32 v4, 12, v2
  v_add_f32_dpp v38, v38, v38 quad_perm:[2,3,0,1] row_mask:0xf bank_mask:0xf
  v_mov_b32 v39, v38
  v_add_u32 v4, s7, v4
  v_lshlrev_b32 v4, 2, v4
  v_permlane16_swap_b32 v39, v38
  v_add_f32 v38, v38, v39
  v_mov_b32 v39, v38
  ds_write_b128 v7, v[28:31] offset:4096
  ds_write_b128 v7, v[32:35] offset:4112
  v_permlane32_swap_b32 v39, v38
  v_add_f32 v38, v38, v39
  ds_write_b32 v4, v36 offset:2576
  ds_write_b32 v4, v38 offset:2640
  v_mov_b32 v56, 0
  v_mov_b32 v58, 0
  v_mov_b32 v59, 1
  v_mov_b32 v48, -4
  v_mov_b32 v36, 0xff7fffff
  v_mov_b32 v38, 0
  v_mov_b32 v28, 0
  v_mov_b32 v29, 0
  v_mov_b32 v30, 0
  v_mov_b32 v31, 0
  v_mov_b32 v32, 0
  v_mov_b32 v33, 0
  v_mov_b32 v34, 0
  v_mov_b32 v35, 0
  v_subrev_u32 v42, 8192, v42
  s_mov_b32 s14, s18
  s_mov_b32 s15, s19
  s_mov_b32 s42, 1
  s_mov_b32 s36, 7
  s_waitcnt lgkmcnt(0)
  s_branch L_K
L_last:
  s_mov_b32 s43, 1048576
  s_waitcnt lgkmcnt(0)
  v_fma_f32 v60, v52, s37, -v37
  v_fma_f32 v61, v53, s37, -v37
  v_fma_f32 v62, v54, s37, -v37
  v_fma_f32 v63, v55, s37, -v37
  v_exp_f32 v60, v60
  v_exp_f32 v61, v61
  v_exp_f32 v62, v62
  v_exp_f32 v63, v63
  v_add_f32 v38, v38, v60
  v_add_f32 v38, v38, v61
  v_add_f32 v38, v38, v62
  v_add_f32 v38, v38, v63
  v_cvt_pk_bf16_f32 v60, v60, v60
  v_cvt_pk_bf16_f32 v61, v61, v61
  v_cvt_pk_bf16_f32 v62, v62, v62
  v_cvt_pk_bf16_f32 v63, v63, v63
  v_readlane_b32 s28, v20, s32
  s_add_u32 s32, s32, 1
  s_cmp_eq_u32 s32, 0
  v_and_b32_dpp v22, v60, v5 quad_perm:[0,0,0,0] row_mask:0xf bank_mask:0xf
  v_and_b32_dpp v23, v60, v6 quad_perm:[0,0,0,0] row_mask:0xf bank_mask:0xf
  v_xor_b32 v3, s28, v8
  s_nop 0
  v_mfma_f32_16x16x16_bf16 v[28:31], v[22:23], v[64:65], v[28:31]
  v_mfma_f32_16x16x16_bf16 v[32:35], v[22:23], v[66:67], v[32:35]
  s_waitcnt vmcnt(11)
  s_cbranch_scc1 L_b1
  s_waitcnt vmcnt(4)
L_b1:
  buffer_load_dwordx4 v[64:67], v3, s[24:27], 0 offen nt
  s_mov_b64 exec, 1
  ds_add_rtn_u32 v56, v58, v59 offset:2560
  s_mov_b64 exec, -1
  v_and_b32_dpp v22, v60, v5 quad_perm:[1,1,1,1] row_mask:0xf bank_mask:0xf
  v_and_b32_dpp v23, v60, v6 quad_perm:[1,1,1,1] row_mask:0xf bank_mask:0xf
  v_xor_b32 v3, s28, v9
  s_nop 0
  v_mfma_f32_16x16x16_bf16 v[28:31], v[22:23], v[68:69], v[28:31]
  v_mfma_f32_16x16x16_bf16 v[32:35], v[22:23], v[70:71], v[32:35]
  s_waitcnt vmcnt(11)
  s_cbranch_scc1 L_b2
  s_waitcnt vmcnt(4)
L_b2:
  buffer_load_dwordx4 v[68:71], v3, s[24:27], 0 offen nt
  v_and_b32_dpp v22, v60, v5 quad_perm:[2,2,2,2] row_mask:0xf bank_mask:0xf
  v_and_b32_dpp v23, v60, v6 quad_perm:[2,2,2,2] row_mask:0xf bank_mask:0xf
  v_xor_b32 v3, s28, v10
  s_nop 0
  v_mfma_f32_16x16x16_bf16 v[28:31], v[22:23], v[72:73], v[28:31]
  v_mfma_f32_16x16x16_bf16 v[32:35], v[22:23], v[74:75], v[32:35]
  s_waitcnt vmcnt(11)
  s_cbranch_scc1 L_b3
  s_waitcnt vmcnt(4)
L_b3:
  buffer_load_dwordx4 v[72:75], v3, s[24:27], 0 offen nt
  v_and_b32_dpp v22, v60, v5 quad_perm:[3,3,3,3] row_mask:0xf bank_mask:0xf
  v_and_b32_dpp v23, v60, v6 quad_perm:[3,3,3,3] row_mask:0xf bank_mask:0xf
  v_xor_b32 v3, s28, v11
  s_nop 0
  v_mfma_f32_16x16x16_bf16 v[28:31], v[22:23], v[76:77], v[28:31]
  v_mfma_f32_16x16x16_bf16 v[32:35], v[22:23], v[78:79], v[32:35]
  s_waitcnt vmcnt(11)
  s_cbranch_scc1 L_b4
  s_waitcnt vmcnt(4)
L_b4:
  buffer_load_dwordx4 v[76:79], v3, s[24:27], 0 offen nt
  v_and_b32_dpp v22, v61, v5 quad_perm:[0,0,0,0] row_mask:0xf bank_mask:0xf
  v_and_b32_dpp v23, v61, v6 quad_perm:[0,0,0,0] row_mask:0xf bank_mask:0xf
  v_xor_b32 v3, s28, v12
  s_nop 0
  v_mfma_f32_16x16x16_bf16 v[28:31], v[22:23], v[80:81], v[28:31]
  v_mfma_f32_16x16x16_bf16 v[32:35], v[22:23], v[82:83], v[32:35]
  s_waitcnt vmcnt(11)
  s_cbranch_scc1 L_b5
  s_waitcnt vmcnt(4)
L_b5:
  buffer_load_dwordx4 v[80:83], v3, s[20:23], 0 offen nt
  v_and_b32_dpp v22, v61, v5 quad_perm:[1,1,1,1] row_mask:0xf bank_mask:0xf
  v_and_b32_dpp v23, v61, v6 quad_perm:[1,1,1,1] row_mask:0xf bank_mask:0xf
  v_xor_b32 v3, s28, v13
  s_nop 0
  v_mfma_f32_16x16x16_bf16 v[28:31], v[22:23], v[84:85], v[28:31]
  v_mfma_f32_16x16x16_bf16 v[32:35], v[22:23], v[86:87], v[32:35]
  s_waitcnt vmcnt(11)
  s_cbranch_scc1 L_b6
  s_waitcnt vmcnt(4)
L_b6:
  buffer_load_dwordx4 v[84:87], v3, s[20:23], 0 offen nt
  v_and_b32_dpp v22, v61, v5 quad_perm:[2,2,2,2] row_mask:0xf bank_mask:0xf
  v_and_b32_dpp v23, v61, v6 quad_perm:[2,2,2,2] row_mask:0xf bank_mask:0xf
  v_xor_b32 v3, s28, v14
  s_nop 0
  v_mfma_f32_16x16x16_bf16 v[28:31], v[22:23], v[88:89], v[28:31]
  v_mfma_f32_16x16x16_bf16 v[32:35], v[22:23], v[90:91], v[32:35]
  s_waitcnt vmcnt(11)
  s_cbranch_scc1 L_b7
  s_waitcnt vmcnt(4)
L_b7:
  buffer_load_dwordx4 v[88:91], v3, s[20:23], 0 offen nt
  s_waitcnt lgkmcnt(0)
  v_readfirstlane_b32 s44, v56
  s_nop 1
  v_and_b32 v56, s44, v48
  ds_read_b32 v57, v56 offset:3200
  v_and_b32_dpp v22, v61, v5 quad_perm:[3,3,3,3] row_mask:0xf bank_mask:0xf
  v_and_b32_dpp v23, v61, v6 quad_perm:[3,3,3,3] row_mask:0xf bank_mask:0xf
  v_xor_b32 v3, s28, v15
  s_nop 0
  v_mfma_f32_16x16x16_bf16 v[28:31], v[22:23], v[92:93], v[28:31]
  v_mfma_f32_16x16x16_bf16 v[32:35], v[22:23], v[94:95], v[32:35]
  s_waitcnt vmcnt(11)
  s_cbranch_scc1 L_b8
  s_waitcnt vmcnt(4)
L_b8:
  buffer_load_dwordx4 v[92:95], v3, s[20:23], 0 offen nt
  s_branch L_tk9
L_tr9:
  ds_read_b32 v57, v56 offset:3200
  s_sub_u32 s43, s43, 1
  s_cbranch_scc1 L_send
L_tk9:
  s_waitcnt lgkmcnt(0)
  v_readfirstlane_b32 s38, v57
  s_cmp_lt_i32 s38, 0
  s_cbranch_scc1 L_tr9
  s_cmp_ge_u32 s38, 64
  s_cbranch_scc1 L_xp1
  v_readlane_b32 s28, v21, s38
  s_bitcmp1_b32 s44, 0
  s_cselect_b32 s29, 0x221500, 0
  s_xor_b32 s28, s28, s29
  s_bitcmp1_b32 s44, 1
  s_cselect_b32 s29, 0x6bef00, 0
  s_xor_b32 s28, s28, s29
  s_cmp_ge_u32 s38, 56
  v_and_b32_dpp v22, v62, v5 quad_perm:[0,0,0,0] row_mask:0xf bank_mask:0xf
  v_and_b32_dpp v23, v62, v6 quad_perm:[0,0,0,0] row_mask:0xf bank_mask:0xf
  v_xor_b32 v3, s28, v8
  s_nop 0
  v_mfma_f32_16x16x16_bf16 v[28:31], v[22:23], v[96:97], v[28:31]
  v_mfma_f32_16x16x16_bf16 v[32:35], v[22:23], v[98:99], v[32:35]
  s_waitcnt vmcnt(11)
  s_cbranch_scc1 L_b10
  s_waitcnt vmcnt(4)
L_b10:
  buffer_load_dwordx4 v[96:99], v3, s[24:27], 0 offen nt
  s_mov_b64 exec, 1
  ds_add_rtn_u32 v56, v58, v59 offset:2560
  s_mov_b64 exec, -1
  v_and_b32_dpp v22, v62, v5 quad_perm:[1,1,1,1] row_mask:0xf bank_mask:0xf
  v_and_b32_dpp v23, v62, v6 quad_perm:[1,1,1,1] row_mask:0xf bank_mask:0xf
  v_xor_b32 v3, s28, v9
  s_nop 0
  v_mfma_f32_16x16x16_bf16 v[28:31], v[22:23], v[100:101], v[28:31]
  v_mfma_f32_16x16x16_bf16 v[32:35], v[22:23], v[102:103], v[32:35]
  s_waitcnt vmcnt(11)
  s_cbranch_scc1 L_b11
  s_waitcnt vmcnt(4)
L_b11:
  buffer_load_dwordx4 v[100:103], v3, s[24:27], 0 offen nt
  v_and_b32_dpp v22, v62, v5 quad_perm:[2,2,2,2] row_mask:0xf bank_mask:0xf
  v_and_b32_dpp v23, v62, v6 quad_perm:[2,2,2,2] row_mask:0xf bank_mask:0xf
  v_xor_b32 v3, s28, v10
  s_nop 0
  v_mfma_f32_16x16x16_bf16 v[28:31], v[22:23], v[104:105], v[28:31]
  v_mfma_f32_16x16x16_bf16 v[32:35], v[22:23], v[106:107], v[32:35]
  s_waitcnt vmcnt(11)
  s_cbranch_scc1 L_b12
  s_waitcnt vmcnt(4)
L_b12:
  buffer_load_dwordx4 v[104:107], v3, s[24:27], 0 offen nt
  v_and_b32_dpp v22, v62, v5 quad_perm:[3,3,3,3] row_mask:0xf bank_mask:0xf
  v_and_b32_dpp v23, v62, v6 quad_perm:[3,3,3,3] row_mask:0xf bank_mask:0xf
  v_xor_b32 v3, s28, v11
  s_nop 0
  v_mfma_f32_16x16x16_bf16 v[28:31], v[22:23], v[108:109], v[28:31]
  v_mfma_f32_16x16x16_bf16 v[32:35], v[22:23], v[110:111], v[32:35]
  s_waitcnt vmcnt(11)
  s_cbranch_scc1 L_b13
  s_waitcnt vmcnt(4)
L_b13:
  buffer_load_dwordx4 v[108:111], v3, s[24:27], 0 offen nt
  v_and_b32_dpp v22, v63, v5 quad_perm:[0,0,0,0] row_mask:0xf bank_mask:0xf
  v_and_b32_dpp v23, v63, v6 quad_perm:[0,0,0,0] row_mask:0xf bank_mask:0xf
  v_xor_b32 v3, s28, v12
  s_nop 0
  v_mfma_f32_16x16x16_bf16 v[28:31], v[22:23], v[112:113], v[28:31]
  v_mfma_f32_16x16x16_bf16 v[32:35], v[22:23], v[114:115], v[32:35]
  s_waitcnt vmcnt(11)
  s_cbranch_scc1 L_b14
  s_waitcnt vmcnt(4)
L_b14:
  buffer_load_dwordx4 v[112:115], v3, s[20:23], 0 offen nt
  v_and_b32_dpp v22, v63, v5 quad_perm:[1,1,1,1] row_mask:0xf bank_mask:0xf
  v_and_b32_dpp v23, v63, v6 quad_perm:[1,1,1,1] row_mask:0xf bank_mask:0xf
  v_xor_b32 v3, s28, v13
  s_nop 0
  v_mfma_f32_16x16x16_bf16 v[28:31], v[22:23], v[116:117], v[28:31]
  v_mfma_f32_16x16x16_bf16 v[32:35], v[22:23], v[118:119], v[32:35]
  s_waitcnt vmcnt(11)
  s_cbranch_scc1 L_b15
  s_waitcnt vmcnt(4)
L_b15:
  buffer_load_dwordx4 v[116:119], v3, s[20:23], 0 offen nt
  v_and_b32_dpp v22, v63, v5 quad_perm:[2,2,2,2] row_mask:0xf bank_mask:0xf
  v_and_b32_dpp v23, v63, v6 quad_perm:[2,2,2,2] row_mask:0xf bank_mask:0xf
  v_xor_b32 v3, s28, v14
  s_nop 0
  v_mfma_f32_16x16x16_bf16 v[28:31], v[22:23], v[120:121], v[28:31]
  v_mfma_f32_16x16x16_bf16 v[32:35], v[22:23], v[122:123], v[32:35]
  s_waitcnt vmcnt(11)
  s_cbranch_scc1 L_b16
  s_waitcnt vmcnt(4)
L_b16:
  buffer_load_dwordx4 v[120:123], v3, s[20:23], 0 offen nt
  s_waitcnt lgkmcnt(0)
  v_readfirstlane_b32 s44, v56
  s_nop 1
  v_and_b32 v56, s44, v48
  ds_read_b32 v57, v56 offset:3200
  v_and_b32_dpp v22, v63, v5 quad_perm:[3,3,3,3] row_mask:0xf bank_mask:0xf
  v_and_b32_dpp v23, v63, v6 quad_perm:[3,3,3,3] row_mask:0xf bank_mask:0xf
  v_xor_b32 v3, s28, v15
  s_nop 0
  v_mfma_f32_16x16x16_bf16 v[28:31], v[22:23], v[124:125], v[28:31]
  v_mfma_f32_16x16x16_bf16 v[32:35], v[22:23], v[126:127], v[32:35]
  s_waitcnt vmcnt(11)
  s_cbranch_scc1 L_b17
  s_waitcnt vmcnt(4)
L_b17:
  buffer_load_dwordx4 v[124:127], v3, s[20:23], 0 offen nt
L_dyn:
  s_branch L_tk18
L_tr18:
  ds_read_b32 v57, v56 offset:3200
  s_sub_u32 s43, s43, 1
  s_cbranch_scc1 L_send
L_tk18:
  s_waitcnt lgkmcnt(0)
  v_readfirstlane_b32 s38, v57
  s_cmp_lt_i32 s38, 0
  s_cbranch_scc1 L_tr18
  s_cmp_ge_u32 s38, 64
  s_cbranch_scc1 L_xd0
  v_readlane_b32 s28, v21, s38
  s_bitcmp1_b32 s44, 0
  s_cselect_b32 s29, 0x221500, 0
  s_xor_b32 s28, s28, s29
  s_bitcmp1_b32 s44, 1
  s_cselect_b32 s29, 0x6bef00, 0
  s_xor_b32 s28, s28, s29
  s_cmp_ge_u32 s38, 56
  v_mfma_f32_16x16x32_bf16 v[44:47], v[64:67], v[24:27], 0
  v_xor_b32 v3, s28, v8
  s_waitcnt vmcnt(11)
  s_cbranch_scc1 L_b19
  s_waitcnt vmcnt(4)
L_b19:
  buffer_load_dwordx4 v[64:67], v3, s[24:27], 0 offen nt
  s_nop 4
  v_mov_b32_dpp v41, v44 quad_perm:[0,0,0,0] row_mask:0xf bank_mask:0xf
  v_add_f32_dpp v41, v45, v41 quad_perm:[1,1,1,1] row_mask:0xf bank_mask:0xf
  v_add_f32_dpp v41, v46, v41 quad_perm:[2,2,2,2] row_mask:0xf bank_mask:0xf
  v_add_f32_dpp v52, v47, v41 quad_perm:[3,3,3,3] row_mask:0xf bank_mask:0xf
  s_mov_b64 exec, 1
  ds_add_rtn_u32 v56, v58, v59 offset:2560
  s_mov_b64 exec, -1
  v_mfma_f32_16x16x32_bf16 v[44:47], v[68:71], v[24:27], 0
  v_xor_b32 v3, s28, v9
  s_waitcnt vmcnt(11)
  s_cbranch_scc1 L_b20
  s_waitcnt vmcnt(4)
L_b20:
  buffer_load_dwordx4 v[68:71], v3, s[24:27], 0 offen nt
  s_nop 4
  v_mov_b32_dpp v41, v44 quad_perm:[0,0,0,0] row_mask:0xf bank_mask:0xf
  v_add_f32_dpp v41, v45, v41 quad_perm:[1,1,1,1] row_mask:0xf bank_mask:0xf
  v_add_f32_dpp v41, v46, v41 quad_perm:[2,2,2,2] row_mask:0xf bank_mask:0xf
  v_add_f32_dpp v41, v47, v41 quad_perm:[3,3,3,3] row_mask:0xf bank_mask:0xf
  v_cndmask_b32 v52, v52, v41, s[52:53]
  v_mfma_f32_16x16x32_bf16 v[44:47], v[72:75], v[24:27], 0
  v_xor_b32 v3, s28, v10
  s_waitcnt vmcnt(11)
  s_cbranch_scc1 L_b21
  s_waitcnt vmcnt(4)
L_b21:
  buffer_load_dwordx4 v[72:75], v3, s[24:27], 0 offen nt
  s_nop 4
  v_mov_b32_dpp v41, v44 quad_perm:[0,0,0,0] row_mask:0xf bank_mask:0xf
  v_add_f32_dpp v41, v45, v41 quad_perm:[1,1,1,1] row_mask:0xf bank_mask:0xf
  v_add_f32_dpp v41, v46, v41 quad_perm:[2,2,2,2] row_mask:0xf bank_mask:0xf
  v_add_f32_dpp v41, v47, v41 quad_perm:[3,3,3,3] row_mask:0xf bank_mask:0xf
  v_cndmask_b32 v52, v52, v41, s[54:55]
  v_mfma_f32_16x16x32_bf16 v[44:47], v[76:79], v[24:27], 0
  v_xor_b32 v3, s28, v11
  s_waitcnt vmcnt(11)
  s_cbranch_scc1 L_b22
  s_waitcnt vmcnt(4)
L_b22:
  buffer_load_dwordx4 v[76:79], v3, s[24:27], 0 offen nt
  s_nop 4
  v_mov_b32_dpp v41, v44 quad_perm:[0,0,0,0] row_mask:0xf bank_mask:0xf
  v_add_f32_dpp v41, v45, v41 quad_perm:[1,1,1,1] row_mask:0xf bank_mask:0xf
  v_add_f32_dpp v41, v46, v41 quad_perm:[2,2,2,2] row_mask:0xf bank_mask:0xf
  v_add_f32_dpp v41, v47, v41 quad_perm:[3,3,3,3] row_mask:0xf bank_mask:0xf
  v_cndmask_b32 v52, v52, v41, s[56:57]
  v_cmp_gt_f32 vcc, v52, v36
  s_cbranch_vccnz Lrare_d0
Lback_d0:
  v_fma_f32 v60, v52, s37, -v37
  v_exp_f32 v60, v60
  s_nop 0
  v_add_f32 v38, v38, v60
  v_cvt_pk_bf16_f32 v60, v60, v60
  s_nop 1
  v_and_b32_dpp v22, v60, v5 quad_perm:[0,0,0,0] row_mask:0xf bank_mask:0xf
  v_and_b32_dpp v23, v60, v6 quad_perm:[0,0,0,0] row_mask:0xf bank_mask:0xf
  v_xor_b32 v3, s28, v12
  s_nop 0
  v_mfma_f32_16x16x16_bf16 v[28:31], v[22:23], v[80:81], v[28:31]
  v_mfma_f32_16x16x16_bf16 v[32:35], v[22:23], v[82:83], v[32:35]
  s_waitcnt vmcnt(11)
  s_cbranch_scc1 L_b23
  s_waitcnt vmcnt(4)
L_b23:
  buffer_load_dwordx4 v[80:83], v3, s[20:23], 0 offen nt
  v_and_b32_dpp v22, v60, v5 quad_perm:[1,1,1,1] row_mask:0xf bank_mask:0xf
  v_and_b32_dpp v23, v60, v6 quad_perm:[1,1,1,1] row_mask:0xf bank_mask:0xf
  v_xor_b32 v3, s28, v13
  s_nop 0
  v_mfma_f32_16x16x16_bf16 v[28:31], v[22:23], v[84:85], v[28:31]
  v_mfma_f32_16x16x16_bf16 v[32:35], v[22:23], v[86:87], v[32:35]
  s_waitcnt vmcnt(11)
  s_cbranch_scc1 L_b24
  s_waitcnt vmcnt(4)
L_b24:
  buffer_load_dwordx4 v[84:87], v3, s[20:23], 0 offen nt
  v_and_b32_dpp v22, v60, v5 quad_perm:[2,2,2,2] row_mask:0xf bank_mask:0xf
  v_and_b32_dpp v23, v60, v6 quad_perm:[2,2,2,2] row_mask:0xf bank_mask:0xf
  v_xor_b32 v3, s28, v14
  s_nop 0
  v_mfma_f32_16x16x16_bf16 v[28:31], v[22:23], v[88:89], v[28:31]
  v_mfma_f32_16x16x16_bf16 v[32:35], v[22:23], v[90:91], v[32:35]
  s_waitcnt vmcnt(11)
  s_cbranch_scc1 L_b25
  s_waitcnt vmcnt(4)
L_b25:
  buffer_load_dwordx4 v[88:91], v3, s[20:23], 0 offen nt
  s_waitcnt lgkmcnt(0)
  v_readfirstlane_b32 s44, v56
  s_nop 1
  v_and_b32 v56, s44, v48
  ds_read_b32 v57, v56 offset:3200
  v_and_b32_dpp v22, v60, v5 quad_perm:[3,3,3,3] row_mask:0xf bank_mask:0xf
  v_and_b32_dpp v23, v60, v6 quad_perm:[3,3,3,3] row_mask:0xf bank_mask:0xf
  v_xor_b32 v3, s28, v15
  s_nop 0
  v_mfma_f32_16x16x16_bf16 v[28:31], v[22:23], v[92:93], v[28:31]
  v_mfma_f32_16x16x16_bf16 v[32:35], v[22:23], v[94:95], v[32:35]
  s_waitcnt vmcnt(11)
  s_cbranch_scc1 L_b26
  s_waitcnt vmcnt(4)
L_b26:
  buffer_load_dwordx4 v[92:95], v3, s[20:23], 0 offen nt
  s_branch L_tk27
L_tr27:
  ds_read_b32 v57, v56 offset:3200
  s_sub_u32 s43, s43, 1
  s_cbranch_scc1 L_send
L_tk27:
  s_waitcnt lgkmcnt(0)
  v_readfirstlane_b32 s38, v57
  s_cmp_lt_i32 s38, 0
  s_cbranch_scc1 L_tr27
  s_cmp_ge_u32 s38, 64
  s_cbranch_scc1 L_xd1
  v_readlane_b32 s28, v21, s38
  s_bitcmp1_b32 s44, 0
  s_cselect_b32 s29, 0x221500, 0
  s_xor_b32 s28, s28, s29
  s_bitcmp1_b32 s44, 1
  s_cselect_b32 s29, 0x6bef00, 0
  s_xor_b32 s28, s28, s29
  s_cmp_ge_u32 s38, 56
  v_mfma_f32_16x16x32_bf16 v[44:47], v[96:99], v[24:27], 0
  v_xor_b32 v3, s28, v8
  s_waitcnt vmcnt(11)
  s_cbranch_scc1 L_b28
  s_waitcnt vmcnt(4)
L_b28:
  buffer_load_dwordx4 v[96:99], v3, s[24:27], 0 offen nt
  s_nop 4
  v_mov_b32_dpp v41, v44 quad_perm:[0,0,0,0] row_mask:0xf bank_mask:0xf
  v_add_f32_dpp v41, v45, v41 quad_perm:[1,1,1,1] row_mask:0xf bank_mask:0xf
  v_add_f32_dpp v41, v46, v41 quad_perm:[2,2,2,2] row_mask:0xf bank_mask:0xf
  v_add_f32_dpp v52, v47, v41 quad_perm:[3,3,3,3] row_mask:0xf bank_mask:0xf
  s_mov_b64 exec, 1
  ds_add_rtn_u32 v56, v58, v59 offset:2560
  s_mov_b64 exec, -1
  v_mfma_f32_16x16x32_bf16 v[44:47], v[100:103], v[24:27], 0
  v_xor_b32 v3, s28, v9
  s_waitcnt vmcnt(11)
  s_cbranch_scc1 L_b29
  s_waitcnt vmcnt(4)
L_b29:
  buffer_load_dwordx4 v[100:103], v3, s[24:27], 0 offen nt
  s_nop 4
  v_mov_b32_dpp v41, v44 quad_perm:[0,0,0,0] row_mask:0xf bank_mask:0xf
  v_add_f32_dpp v41, v45, v41 quad_perm:[1,1,1,1] row_mask:0xf bank_mask:0xf
  v_add_f32_dpp v41, v46, v41 quad_perm:[2,2,2,2] row_mask:0xf bank_mask:0xf
  v_add_f32_dpp v41, v47, v41 quad_perm:[3,3,3,3] row_mask:0xf bank_mask:0xf
  v_cndmask_b32 v52, v52, v41, s[52:53]
  v_mfma_f32_16x16x32_bf16 v[44:47], v[104:107], v[24:27], 0
  v_xor_b32 v3, s28, v10
  s_waitcnt vmcnt(11)
  s_cbranch_scc1 L_b30
  s_waitcnt vmcnt(4)
L_b30:
  buffer_load_dwordx4 v[104:107], v3, s[24:27], 0 offen nt
  s_nop 4
  v_mov_b32_dpp v41, v44 quad_perm:[0,0,0,0] row_mask:0xf bank_mask:0xf
  v_add_f32_dpp v41, v45, v41 quad_perm:[1,1,1,1] row_mask:0xf bank_mask:0xf
  v_add_f32_dpp v41, v46, v41 quad_perm:[2,2,2,2] row_mask:0xf bank_mask:0xf
  v_add_f32_dpp v41, v47, v41 quad_perm:[3,3,3,3] row_mask:0xf bank_mask:0xf
  v_cndmask_b32 v52, v52, v41, s[54:55]
  v_mfma_f32_16x16x32_bf16 v[44:47], v[108:111], v[24:27], 0
  v_xor_b32 v3, s28, v11
  s_waitcnt vmcnt(11)
  s_cbranch_scc1 L_b31
  s_waitcnt vmcnt(4)
L_b31:
  buffer_load_dwordx4 v[108:111], v3, s[24:27], 0 offen nt
  s_nop 4
  v_mov_b32_dpp v41, v44 quad_perm:[0,0,0,0] row_mask:0xf bank_mask:0xf
  v_add_f32_dpp v41, v45, v41 quad_perm:[1,1,1,1] row_mask:0xf bank_mask:0xf
  v_add_f32_dpp v41, v46, v41 quad_perm:[2,2,2,2] row_mask:0xf bank_mask:0xf
  v_add_f32_dpp v41, v47, v41 quad_perm:[3,3,3,3] row_mask:0xf bank_mask:0xf
  v_cndmask_b32 v52, v52, v41, s[56:57]
  v_cmp_gt_f32 vcc, v52, v36
  s_cbranch_vccnz Lrare_d1
Lback_d1:
  v_fma_f32 v60, v52, s37, -v37
  v_exp_f32 v60, v60
  s_nop 0
  v_add_f32 v38, v38, v60
  v_cvt_pk_bf16_f32 v60, v60, v60
  s_nop 1
  v_and_b32_dpp v22, v60, v5 quad_perm:[0,0,0,0] row_mask:0xf bank_mask:0xf
  v_and_b32_dpp v23, v60, v6 quad_perm:[0,0,0,0] row_mask:0xf bank_mask:0xf
  v_xor_b32 v3, s28, v12
  s_nop 0
  v_mfma_f32_16x16x16_bf16 v[28:31], v[22:23], v[112:113], v[28:31]
  v_mfma_f32_16x16x16_bf16 v[32:35], v[22:23], v[114:115], v[32:35]
  s_waitcnt vmcnt(11)
  s_cbranch_scc1 L_b32
  s_waitcnt vmcnt(4)
L_b32:
  buffer_load_dwordx4 v[112:115], v3, s[20:23], 0 offen nt
  v_and_b32_dpp v22, v60, v5 quad_perm:[1,1,1,1] row_mask:0xf bank_mask:0xf
  v_and_b32_dpp v23, v60, v6 quad_perm:[1,1,1,1] row_mask:0xf bank_mask:0xf
  v_xor_b32 v3, s28, v13
  s_nop 0
  v_mfma_f32_16x16x16_bf16 v[28:31], v[22:23], v[116:117], v[28:31]
  v_mfma_f32_16x16x16_bf16 v[32:35], v[22:23], v[118:119], v[32:35]
  s_waitcnt vmcnt(11)
  s_cbranch_scc1 L_b33
  s_waitcnt vmcnt(4)
L_b33:
  buffer_load_dwordx4 v[116:119], v3, s[20:23], 0 offen nt
  v_and_b32_dpp v22, v60, v5 quad_perm:[2,2,2,2] row_mask:0xf bank_mask:0xf
  v_and_b32_dpp v23, v60, v6 quad_perm:[2,2,2,2] row_mask:0xf bank_mask:0xf
  v_xor_b32 v3, s28, v14
  s_nop 0
  v_mfma_f32_16x16x16_bf16 v[28:31], v[22:23], v[120:121], v[28:31]
  v_mfma_f32_16x16x16_bf16 v[32:35], v[22:23], v[122:123], v[32:35]
  s_waitcnt vmcnt(11)
  s_cbranch_scc1 L_b34
  s_waitcnt vmcnt(4)
L_b34:
  buffer_load_dwordx4 v[120:123], v3, s[20:23], 0 offen nt
  s_waitcnt lgkmcnt(0)
  v_readfirstlane_b32 s44, v56
  s_nop 1
  v_and_b32 v56, s44, v48
  ds_read_b32 v57, v56 offset:3200
  v_and_b32_dpp v22, v60, v5 quad_perm:[3,3,3,3] row_mask:0xf bank_mask:0xf
  v_and_b32_dpp v23, v60, v6 quad_perm:[3,3,3,3] row_mask:0xf bank_mask:0xf
  v_xor_b32 v3, s28, v15
  s_nop 0
  v_mfma_f32_16x16x16_bf16 v[28:31], v[22:23], v[124:125], v[28:31]
  v_mfma_f32_16x16x16_bf16 v[32:35], v[22:23], v[126:127], v[32:35]
  s_waitcnt vmcnt(11)
  s_cbranch_scc1 L_b35
  s_waitcnt vmcnt(4)
L_b35:
  buffer_load_dwordx4 v[124:127], v3, s[20:23], 0 offen nt
  s_branch L_dyn
L_xp1:
  v_and_b32_dpp v22, v62, v5 quad_perm:[0,0,0,0] row_mask:0xf bank_mask:0xf
  v_and_b32_dpp v23, v62, v6 quad_perm:[0,0,0,0] row_mask:0xf bank_mask:0xf
  s_nop 0
  s_nop 0
  v_mfma_f32_16x16x16_bf16 v[28:31], v[22:23], v[96:97], v[28:31]
  v_mfma_f32_16x16x16_bf16 v[32:35], v[22:23], v[98:99], v[32:35]
  v_and_b32_dpp v22, v62, v5 quad_perm:[1,1,1,1] row_mask:0xf bank_mask:0xf
  v_and_b32_dpp v23, v62, v6 quad_perm:[1,1,1,1] row_mask:0xf bank_mask:0xf
  s_nop 0
  s_nop 0
  v_mfma_f32_16x16x16_bf16 v[28:31], v[22:23], v[100:101], v[28:31]
  v_mfma_f32_16x16x16_bf16 v[32:35], v[22:23], v[102:103], v[32:35]
  v_and_b32_dpp v22, v62, v5 quad_perm:[2,2,2,2] row_mask:0xf bank_mask:0xf
  v_and_b32_dpp v23, v62, v6 quad_perm:[2,2,2,2] row_mask:0xf bank_mask:0xf
  s_nop 0
  s_nop 0
  v_mfma_f32_16x16x16_bf16 v[28:31], v[22:23], v[104:105], v[28:31]
  v_mfma_f32_16x16x16_bf16 v[32:35], v[22:23], v[106:107], v[32:35]
  v_and_b32_dpp v22, v62, v5 quad_perm:[3,3,3,3] row_mask:0xf bank_mask:0xf
  v_and_b32_dpp v23, v62, v6 quad_perm:[3,3,3,3] row_mask:0xf bank_mask:0xf
  s_nop 0
  s_nop 0
  v_mfma_f32_16x16x16_bf16 v[28:31], v[22:23], v[108:109], v[28:31]
  v_mfma_f32_16x16x16_bf16 v[32:35], v[22:23], v[110:111], v[32:35]
  v_and_b32_dpp v22, v63, v5 quad_perm:[0,0,0,0] row_mask:0xf bank_mask:0xf
  v_and_b32_dpp v23, v63, v6 quad_perm:[0,0,0,0] row_mask:0xf bank_mask:0xf
  s_waitcnt vmcnt(11)
  s_nop 0
  v_mfma_f32_16x16x16_bf16 v[28:31], v[22:23], v[112:113], v[28:31]
  v_mfma_f32_16x16x16_bf16 v[32:35], v[22:23], v[114:115], v[32:35]
  v_and_b32_dpp v22, v63, v5 quad_perm:[1,1,1,1] row_mask:0xf bank_mask:0xf
  v_and_b32_dpp v23, v63, v6 quad_perm:[1,1,1,1] row_mask:0xf bank_mask:0xf
  s_waitcnt vmcnt(10)
  s_nop 0
  v_mfma_f32_16x16x16_bf16 v[28:31], v[22:23], v[116:117], v[28:31]
  v_mfma_f32_16x16x16_bf16 v[32:35], v[22:23], v[118:119], v[32:35]
  v_and_b32_dpp v22, v63, v5 quad_perm:[2,2,2,2] row_mask:0xf bank_mask:0xf
  v_and_b32_dpp v23, v63, v6 quad_perm:[2,2,2,2] row_mask:0xf bank_mask:0xf
  s_waitcnt vmcnt(9)
  s_nop 0
  v_mfma_f32_16x16x16_bf16 v[28:31], v[22:23], v[120:121], v[28:31]
  v_mfma_f32_16x16x16_bf16 v[32:35], v[22:23], v[122:123], v[32:35]
  v_and_b32_dpp v22, v63, v5 quad_perm:[3,3,3,3] row_mask:0xf bank_mask:0xf
  v_and_b32_dpp v23, v63, v6 quad_perm:[3,3,3,3] row_mask:0xf bank_mask:0xf
  s_waitcnt vmcnt(8)
  s_nop 0
  v_mfma_f32_16x16x16_bf16 v[28:31], v[22:23], v[124:125], v[28:31]
  v_mfma_f32_16x16x16_bf16 v[32:35], v[22:23], v[126:127], v[32:35]
  s_waitcnt vmcnt(7)
  v_mfma_f32_16x16x32_bf16 v[160:163], v[64:67], v[24:27], 0
  s_waitcnt vmcnt(6)
  v_mfma_f32_16x16x32_bf16 v[164:167], v[68:71], v[24:27], 0
  s_waitcnt vmcnt(5)
  v_mfma_f32_16x16x32_bf16 v[168:171], v[72:75], v[24:27], 0
  s_waitcnt vmcnt(4)
  v_mfma_f32_16x16x32_bf16 v[172:175], v[76:79], v[24:27], 0
  s_nop 4
  v_mov_b32_dpp v41, v160 quad_perm:[0,0,0,0] row_mask:0xf bank_mask:0xf
  v_add_f32_dpp v41, v161, v41 quad_perm:[1,1,1,1] row_mask:0xf bank_mask:0xf
  v_add_f32_dpp v41, v162, v41 quad_perm:[2,2,2,2] row_mask:0xf bank_mask:0xf
  v_add_f32_dpp v52, v163, v41 quad_perm:[3,3,3,3] row_mask:0xf bank_mask:0xf
  v_mov_b32_dpp v41, v164 quad_perm:[0,0,0,0] row_mask:0xf bank_mask:0xf
  v_add_f32_dpp v41, v165, v41 quad_perm:[1,1,1,1] row_mask:0xf bank_mask:0xf
  v_add_f32_dpp v41, v166, v41 quad_perm:[2,2,2,2] row_mask:0xf bank_mask:0xf
  v_add_f32_dpp v41, v167, v41 quad_perm:[3,3,3,3] row_mask:0xf bank_mask:0xf
  v_cndmask_b32 v52, v52, v41, s[52:53]
  v_mov_b32_dpp v41, v168 quad_perm:[0,0,0,0] row_mask:0xf bank_mask:0xf
  v_add_f32_dpp v41, v169, v41 quad_perm:[1,1,1,1] row_mask:0xf bank_mask:0xf
  v_add_f32_dpp v41, v170, v41 quad_perm:[2,2,2,2] row_mask:0xf bank_mask:0xf
  v_add_f32_dpp v41, v171, v41 quad_perm:[3,3,3,3] row_mask:0xf bank_mask:0xf
  v_cndmask_b32 v52, v52, v41, s[54:55]
  v_mov_b32_dpp v41, v172 quad_perm:[0,0,0,0] row_mask:0xf bank_mask:0xf
  v_add_f32_dpp v41, v173, v41 quad_perm:[1,1,1,1] row_mask:0xf bank_mask:0xf
  v_add_f32_dpp v41, v174, v41 quad_perm:[2,2,2,2] row_mask:0xf bank_mask:0xf
  v_add_f32_dpp v41, v175, v41 quad_perm:[3,3,3,3] row_mask:0xf bank_mask:0xf
  v_cndmask_b32 v52, v52, v41, s[56:57]
  v_cmp_gt_f32 vcc, v52, v36
  s_cbranch_vccnz Lrare_e1
Lback_e1:
  v_fma_f32 v60, v52, s37, -v37
  v_exp_f32 v60, v60
  s_nop 0
  v_add_f32 v38, v38, v60
  v_cvt_pk_bf16_f32 v60, v60, v60
  s_nop 1
  v_and_b32_dpp v22, v60, v5 quad_perm:[0,0,0,0] row_mask:0xf bank_mask:0xf
  v_and_b32_dpp v23, v60, v6 quad_perm:[0,0,0,0] row_mask:0xf bank_mask:0xf
  s_waitcnt vmcnt(3)
  s_nop 0
  v_mfma_f32_16x16x16_bf16 v[28:31], v[22:23], v[80:81], v[28:31]
  v_mfma_f32_16x16x16_bf16 v[32:35], v[22:23], v[82:83], v[32:35]
  v_and_b32_dpp v22, v60, v5 quad_perm:[1,1,1,1] row_mask:0xf bank_mask:0xf
  v_and_b32_dpp v23, v60, v6 quad_perm:[1,1,1,1] row_mask:0xf bank_mask:0xf
  s_waitcnt vmcnt(2)
  s_nop 0
  v_mfma_f32_16x16x16_bf16 v[28:31], v[22:23], v[84:85], v[28:31]
  v_mfma_f32_16x16x16_bf16 v[32:35], v[22:23], v[86:87], v[32:35]
  v_and_b32_dpp v22, v60, v5 quad_perm:[2,2,2,2] row_mask:0xf bank_mask:0xf
  v_and_b32_dpp v23, v60, v6 quad_perm:[2,2,2,2] row_mask:0xf bank_mask:0xf
  s_waitcnt vmcnt(1)
  s_nop 0
  v_mfma_f32_16x16x16_bf16 v[28:31], v[22:23], v[88:89], v[28:31]
  v_mfma_f32_16x16x16_bf16 v[32:35], v[22:23], v[90:91], v[32:35]
  v_and_b32_dpp v22, v60, v5 quad_perm:[3,3,3,3] row_mask:0xf bank_mask:0xf
  v_and_b32_dpp v23, v60, v6 quad_perm:[3,3,3,3] row_mask:0xf bank_mask:0xf
  s_waitcnt vmcnt(0)
  s_nop 0
  v_mfma_f32_16x16x16_bf16 v[28:31], v[22:23], v[92:93], v[28:31]
  v_mfma_f32_16x16x16_bf16 v[32:35], v[22:23], v[94:95], v[32:35]
  s_branch L_fin
L_xd0:
  v_mfma_f32_16x16x32_bf16 v[160:163], v[64:67], v[24:27], 0
  v_mfma_f32_16x16x32_bf16 v[164:167], v[68:71], v[24:27], 0
  v_mfma_f32_16x16x32_bf16 v[168:171], v[72:75], v[24:27], 0
  v_mfma_f32_16x16x32_bf16 v[172:175], v[76:79], v[24:27], 0
  s_nop 4
  v_mov_b32_dpp v41, v160 quad_perm:[0,0,0,0] row_mask:0xf bank_mask:0xf
  v_add_f32_dpp v41, v161, v41 quad_perm:[1,1,1,1] row_mask:0xf bank_mask:0xf
  v_add_f32_dpp v41, v162, v41 quad_perm:[2,2,2,2] row_mask:0xf bank_mask:0xf
  v_add_f32_dpp v52, v163, v41 quad_perm:[3,3,3,3] row_mask:0xf bank_mask:0xf
  v_mov_b32_dpp v41, v164 quad_perm:[0,0,0,0] row_mask:0xf bank_mask:0xf
  v_add_f32_dpp v41, v165, v41 quad_perm:[1,1,1,1] row_mask:0xf bank_mask:0xf
  v_add_f32_dpp v41, v166, v41 quad_perm:[2,2,2,2] row_mask:0xf bank_mask:0xf
  v_add_f32_dpp v41, v167, v41 quad_perm:[3,3,3,3] row_mask:0xf bank_mask:0xf
  v_cndmask_b32 v52, v52, v41, s[52:53]
  v_mov_b32_dpp v41, v168 quad_perm:[0,0,0,0] row_mask:0xf bank_mask:0xf
  v_add_f32_dpp v41, v169, v41 quad_perm:[1,1,1,1] row_mask:0xf bank_mask:0xf
  v_add_f32_dpp v41, v170, v41 quad_perm:[2,2,2,2] row_mask:0xf bank_mask:0xf
  v_add_f32_dpp v41, v171, v41 quad_perm:[3,3,3,3] row_mask:0xf bank_mask:0xf
  v_cndmask_b32 v52, v52, v41, s[54:55]
  v_mov_b32_dpp v41, v172 quad_perm:[0,0,0,0] row_mask:0xf bank_mask:0xf
  v_add_f32_dpp v41, v173, v41 quad_perm:[1,1,1,1] row_mask:0xf bank_mask:0xf
  v_add_f32_dpp v41, v174, v41 quad_perm:[2,2,2,2] row_mask:0xf bank_mask:0xf
  v_add_f32_dpp v41, v175, v41 quad_perm:[3,3,3,3] row_mask:0xf bank_mask:0xf
  v_cndmask_b32 v52, v52, v41, s[56:57]
  v_cmp_gt_f32 vcc, v52, v36
  s_cbranch_vccnz Lrare_e2
Lback_e2:
  v_fma_f32 v60, v52, s37, -v37
  v_exp_f32 v60, v60
  s_nop 0
  v_add_f32 v38, v38, v60
  v_cvt_pk_bf16_f32 v60, v60, v60
  s_nop 1
  v_and_b32_dpp v22, v60, v5 quad_perm:[0,0,0,0] row_mask:0xf bank_mask:0xf
  v_and_b32_dpp v23, v60, v6 quad_perm:[0,0,0,0] row_mask:0xf bank_mask:0xf
  s_waitcnt vmcnt(11)
  s_nop 0
  v_mfma_f32_16x16x16_bf16 v[28:31], v[22:23], v[80:81], v[28:31]
  v_mfma_f32_16x16x16_bf16 v[32:35], v[22:23], v[82:83], v[32:35]
  v_and_b32_dpp v22, v60, v5 quad_perm:[1,1,1,1] row_mask:0xf bank_mask:0xf
  v_and_b32_dpp v23, v60, v6 quad_perm:[1,1,1,1] row_mask:0xf bank_mask:0xf
  s_waitcnt vmcnt(10)
  s_nop 0
  v_mfma_f32_16x16x16_bf16 v[28:31], v[22:23], v[84:85], v[28:31]
  v_mfma_f32_16x16x16_bf16 v[32:35], v[22:23], v[86:87], v[32:35]
  v_and_b32_dpp v22, v60, v5 quad_perm:[2,2,2,2] row_mask:0xf bank_mask:0xf
  v_and_b32_dpp v23, v60, v6 quad_perm:[2,2,2,2] row_mask:0xf bank_mask:0xf
  s_waitcnt vmcnt(9)
  s_nop 0
  v_mfma_f32_16x16x16_bf16 v[28:31], v[22:23], v[88:89], v[28:31]
  v_mfma_f32_16x16x16_bf16 v[32:35], v[22:23], v[90:91], v[32:35]
  v_and_b32_dpp v22, v60, v5 quad_perm:[3,3,3,3] row_mask:0xf bank_mask:0xf
  v_and_b32_dpp v23, v60, v6 quad_perm:[3,3,3,3] row_mask:0xf bank_mask:0xf
  s_waitcnt vmcnt(8)
  s_nop 0
  v_mfma_f32_16x16x16_bf16 v[28:31], v[22:23], v[92:93], v[28:31]
  v_mfma_f32_16x16x16_bf16 v[32:35], v[22:23], v[94:95], v[32:35]
  s_waitcnt vmcnt(7)
  v_mfma_f32_16x16x32_bf16 v[160:163], v[96:99], v[24:27], 0
  s_waitcnt vmcnt(6)
  v_mfma_f32_16x16x32_bf16 v[164:167], v[100:103], v[24:27], 0
  s_waitcnt vmcnt(5)
  v_mfma_f32_16x16x32_bf16 v[168:171], v[104:107], v[24:27], 0
  s_waitcnt vmcnt(4)
  v_mfma_f32_16x16x32_bf16 v[172:175], v[108:111], v[24:27], 0
  s_nop 4
  v_mov_b32_dpp v41, v160 quad_perm:[0,0,0,0] row_mask:0xf bank_mask:0xf
  v_add_f32_dpp v41, v161, v41 quad_perm:[1,1,1,1] row_mask:0xf bank_mask:0xf
  v_add_f32_dpp v41, v162, v41 quad_perm:[2,2,2,2] row_mask:0xf bank_mask:0xf
  v_add_f32_dpp v52, v163, v41 quad_perm:[3,3,3,3] row_mask:0xf bank_mask:0xf
  v_mov_b32_dpp v41, v164 quad_perm:[0,0,0,0] row_mask:0xf bank_mask:0xf
  v_add_f32_dpp v41, v165, v41 quad_perm:[1,1,1,1] row_mask:0xf bank_mask:0xf
  v_add_f32_dpp v41, v166, v41 quad_perm:[2,2,2,2] row_mask:0xf bank_mask:0xf
  v_add_f32_dpp v41, v167, v41 quad_perm:[3,3,3,3] row_mask:0xf bank_mask:0xf
  v_cndmask_b32 v52, v52, v41, s[52:53]
  v_mov_b32_dpp v41, v168 quad_perm:[0,0,0,0] row_mask:0xf bank_mask:0xf
  v_add_f32_dpp v41, v169, v41 quad_perm:[1,1,1,1] row_mask:0xf bank_mask:0xf
  v_add_f32_dpp v41, v170, v41 quad_perm:[2,2,2,2] row_mask:0xf bank_mask:0xf
  v_add_f32_dpp v41, v171, v41 quad_perm:[3,3,3,3] row_mask:0xf bank_mask:0xf
  v_cndmask_b32 v52, v52, v41, s[54:55]
  v_mov_b32_dpp v41, v172 quad_perm:[0,0,0,0] row_mask:0xf bank_mask:0xf
  v_add_f32_dpp v41, v173, v41 quad_perm:[1,1,1,1] row_mask:0xf bank_mask:0xf
  v_add_f32_dpp v41, v174, v41 quad_perm:[2,2,2,2] row_mask:0xf bank_mask:0xf
  v_add_f32_dpp v41, v175, v41 quad_perm:[3,3,3,3] row_mask:0xf bank_mask:0xf
  v_cndmask_b32 v52, v52, v41, s[56:57]
  v_cmp_gt_f32 vcc, v52, v36
  s_cbranch_vccnz Lrare_e3
Lback_e3:
  v_fma_f32 v60, v52, s37, -v37
  v_exp_f32 v60, v60
  s_nop 0
  v_add_f32 v38, v38, v60
  v_cvt_pk_bf16_f32 v60, v60, v60
  s_nop 1
  v_and_b32_dpp v22, v60, v5 quad_perm:[0,0,0,0] row_mask:0xf bank_mask:0xf
  v_and_b32_dpp v23, v60, v6 quad_perm:[0,0,0,0] row_mask:0xf bank_mask:0xf
  s_waitcnt vmcnt(3)
  s_nop 0
  v_mfma_f32_16x16x16_bf16 v[28:31], v[22:23], v[112:113], v[28:31]
  v_mfma_f32_16x16x16_bf16 v[32:35], v[22:23], v[114:115], v[32:35]
  v_and_b32_dpp v22, v60, v5 quad_perm:[1,1,1,1] row_mask:0xf bank_mask:0xf
  v_and_b32_dpp v23, v60, v6 quad_perm:[1,1,1,1] row_mask:0xf bank_mask:0xf
  s_waitcnt vmcnt(2)
  s_nop 0
  v_mfma_f32_16x16x16_bf16 v[28:31], v[22:23], v[116:117], v[28:31]
  v_mfma_f32_16x16x16_bf16 v[32:35], v[22:23], v[118:119], v[32:35]
  v_and_b32_dpp v22, v60, v5 quad_perm:[2,2,2,2] row_mask:0xf bank_mask:0xf
  v_and_b32_dpp v23, v60, v6 quad_perm:[2,2,2,2] row_mask:0xf bank_mask:0xf
  s_waitcnt vmcnt(1)
  s_nop 0
  v_mfma_f32_16x16x16_bf16 v[28:31], v[22:23], v[120:121], v[28:31]
  v_mfma_f32_16x16x16_bf16 v[32:35], v[22:23], v[122:123], v[32:35]
  v_and_b32_dpp v22, v60, v5 quad_perm:[3,3,3,3] row_mask:0xf bank_mask:0xf
  v_and_b32_dpp v23, v60, v6 quad_perm:[3,3,3,3] row_mask:0xf bank_mask:0xf
  s_waitcnt vmcnt(0)
  s_nop 0
  v_mfma_f32_16x16x16_bf16 v[28:31], v[22:23], v[124:125], v[28:31]
  v_mfma_f32_16x16x16_bf16 v[32:35], v[22:23], v[126:127], v[32:35]
  s_branch L_fin
L_xd1:
  v_mfma_f32_16x16x32_bf16 v[160:163], v[96:99], v[24:27], 0
  v_mfma_f32_16x16x32_bf16 v[164:167], v[100:103], v[24:27], 0
  v_mfma_f32_16x16x32_bf16 v[168:171], v[104:107], v[24:27], 0
  v_mfma_f32_16x16x32_bf16 v[172:175], v[108:111], v[24:27], 0
  s_nop 4
  v_mov_b32_dpp v41, v160 quad_perm:[0,0,0,0] row_mask:0xf bank_mask:0xf
  v_add_f32_dpp v41, v161, v41 quad_perm:[1,1,1,1] row_mask:0xf bank_mask:0xf
  v_add_f32_dpp v41, v162, v41 quad_perm:[2,2,2,2] row_mask:0xf bank_mask:0xf
  v_add_f32_dpp v52, v163, v41 quad_perm:[3,3,3,3] row_mask:0xf bank_mask:0xf
  v_mov_b32_dpp v41, v164 quad_perm:[0,0,0,0] row_mask:0xf bank_mask:0xf
  v_add_f32_dpp v41, v165, v41 quad_perm:[1,1,1,1] row_mask:0xf bank_mask:0xf
  v_add_f32_dpp v41, v166, v41 quad_perm:[2,2,2,2] row_mask:0xf bank_mask:0xf
  v_add_f32_dpp v41, v167, v41 quad_perm:[3,3,3,3] row_mask:0xf bank_mask:0xf
  v_cndmask_b32 v52, v52, v41, s[52:53]
  v_mov_b32_dpp v41, v168 quad_perm:[0,0,0,0] row_mask:0xf bank_mask:0xf
  v_add_f32_dpp v41, v169, v41 quad_perm:[1,1,1,1] row_mask:0xf bank_mask:0xf
  v_add_f32_dpp v41, v170, v41 quad_perm:[2,2,2,2] row_mask:0xf bank_mask:0xf
  v_add_f32_dpp v41, v171, v41 quad_perm:[3,3,3,3] row_mask:0xf bank_mask:0xf
  v_cndmask_b32 v52, v52, v41, s[54:55]
  v_mov_b32_dpp v41, v172 quad_perm:[0,0,0,0] row_mask:0xf bank_mask:0xf
  v_add_f32_dpp v41, v173, v41 quad_perm:[1,1,1,1] row_mask:0xf bank_mask:0xf
  v_add_f32_dpp v41, v174, v41 quad_perm:[2,2,2,2] row_mask:0xf bank_mask:0xf
  v_add_f32_dpp v41, v175, v41 quad_perm:[3,3,3,3] row_mask:0xf bank_mask:0xf
  v_cndmask_b32 v52, v52, v41, s[56:57]
  v_cmp_gt_f32 vcc, v52, v36
  s_cbranch_vccnz Lrare_e4
Lback_e4:
  v_fma_f32 v60, v52, s37, -v37
  v_exp_f32 v60, v60
  s_nop 0
  v_add_f32 v38, v38, v60
  v_cvt_pk_bf16_f32 v60, v60, v60
  s_nop 1
  v_and_b32_dpp v22, v60, v5 quad_perm:[0,0,0,0] row_mask:0xf bank_mask:0xf
  v_and_b32_dpp v23, v60, v6 quad_perm:[0,0,0,0] row_mask:0xf bank_mask:0xf
  s_waitcnt vmcnt(11)
  s_nop 0
  v_mfma_f32_16x16x16_bf16 v[28:31], v[22:23], v[112:113], v[28:31]
  v_mfma_f32_16x16x16_bf16 v[32:35], v[22:23], v[114:115], v[32:35]
  v_and_b32_dpp v22, v60, v5 quad_perm:[1,1,1,1] row_mask:0xf bank_mask:0xf
  v_and_b32_dpp v23, v60, v6 quad_perm:[1,1,1,1] row_mask:0xf bank_mask:0xf
  s_waitcnt vmcnt(10)
  s_nop 0
  v_mfma_f32_16x16x16_bf16 v[28:31], v[22:23], v[116:117], v[28:31]
  v_mfma_f32_16x16x16_bf16 v[32:35], v[22:23], v[118:119], v[32:35]
  v_and_b32_dpp v22, v60, v5 quad_perm:[2,2,2,2] row_mask:0xf bank_mask:0xf
  v_and_b32_dpp v23, v60, v6 quad_perm:[2,2,2,2] row_mask:0xf bank_mask:0xf
  s_waitcnt vmcnt(9)
  s_nop 0
  v_mfma_f32_16x16x16_bf16 v[28:31], v[22:23], v[120:121], v[28:31]
  v_mfma_f32_16x16x16_bf16 v[32:35], v[22:23], v[122:123], v[32:35]
  v_and_b32_dpp v22, v60, v5 quad_perm:[3,3,3,3] row_mask:0xf bank_mask:0xf
  v_and_b32_dpp v23, v60, v6 quad_perm:[3,3,3,3] row_mask:0xf bank_mask:0xf
  s_waitcnt vmcnt(8)
  s_nop 0
  v_mfma_f32_16x16x16_bf16 v[28:31], v[22:23], v[124:125], v[28:31]
  v_mfma_f32_16x16x16_bf16 v[32:35], v[22:23], v[126:127], v[32:35]
  s_waitcnt vmcnt(7)
  v_mfma_f32_16x16x32_bf16 v[160:163], v[64:67], v[24:27], 0
  s_waitcnt vmcnt(6)
  v_mfma_f32_16x16x32_bf16 v[164:167], v[68:71], v[24:27], 0
  s_waitcnt vmcnt(5)
  v_mfma_f32_16x16x32_bf16 v[168:171], v[72:75], v[24:27], 0
  s_waitcnt vmcnt(4)
  v_mfma_f32_16x16x32_bf16 v[172:175], v[76:79], v[24:27], 0
  s_nop 4
  v_mov_b32_dpp v41, v160 quad_perm:[0,0,0,0] row_mask:0xf bank_mask:0xf
  v_add_f32_dpp v41, v161, v41 quad_perm:[1,1,1,1] row_mask:0xf bank_mask:0xf
  v_add_f32_dpp v41, v162, v41 quad_perm:[2,2,2,2] row_mask:0xf bank_mask:0xf
  v_add_f32_dpp v52, v163, v41 quad_perm:[3,3,3,3] row_mask:0xf bank_mask:0xf
  v_mov_b32_dpp v41, v164 quad_perm:[0,0,0,0] row_mask:0xf bank_mask:0xf
  v_add_f32_dpp v41, v165, v41 quad_perm:[1,1,1,1] row_mask:0xf bank_mask:0xf
  v_add_f32_dpp v41, v166, v41 quad_perm:[2,2,2,2] row_mask:0xf bank_mask:0xf
  v_add_f32_dpp v41, v167, v41 quad_perm:[3,3,3,3] row_mask:0xf bank_mask:0xf
  v_cndmask_b32 v52, v52, v41, s[52:53]
  v_mov_b32_dpp v41, v168 quad_perm:[0,0,0,0] row_mask:0xf bank_mask:0xf
  v_add_f32_dpp v41, v169, v41 quad_perm:[1,1,1,1] row_mask:0xf bank_mask:0xf
  v_add_f32_dpp v41, v170, v41 quad_perm:[2,2,2,2] row_mask:0xf bank_mask:0xf
  v_add_f32_dpp v41, v171, v41 quad_perm:[3,3,3,3] row_mask:0xf bank_mask:0xf
  v_cndmask_b32 v52, v52, v41, s[54:55]
  v_mov_b32_dpp v41, v172 quad_perm:[0,0,0,0] row_mask:0xf bank_mask:0xf
  v_add_f32_dpp v41, v173, v41 quad_perm:[1,1,1,1] row_mask:0xf bank_mask:0xf
  v_add_f32_dpp v41, v174, v41 quad_perm:[2,2,2,2] row_mask:0xf bank_mask:0xf
  v_add_f32_dpp v41, v175, v41 quad_perm:[3,3,3,3] row_mask:0xf bank_mask:0xf
  v_cndmask_b32 v52, v52, v41, s[56:57]
  v_cmp_gt_f32 vcc, v52, v36
  s_cbranch_vccnz Lrare_e5
Lback_e5:
  v_fma_f32 v60, v52, s37, -v37
  v_exp_f32 v60, v60
  s_nop 0
  v_add_f32 v38, v38, v60
  v_cvt_pk_bf16_f32 v60, v60, v60
  s_nop 1
  v_and_b32_dpp v22, v60, v5 quad_perm:[0,0,0,0] row_mask:0xf bank_mask:0xf
  v_and_b32_dpp v23, v60, v6 quad_perm:[0,0,0,0] row_mask:0xf bank_mask:0xf
  s_waitcnt vmcnt(3)
  s_nop 0
  v_mfma_f32_16x16x16_bf16 v[28:31], v[22:23], v[80:81], v[28:31]
  v_mfma_f32_16x16x16_bf16 v[32:35], v[22:23], v[82:83], v[32:35]
  v_and_b32_dpp v22, v60, v5 quad_perm:[1,1,1,1] row_mask:0xf bank_mask:0xf
  v_and_b32_dpp v23, v60, v6 quad_perm:[1,1,1,1] row_mask:0xf bank_mask:0xf
  s_waitcnt vmcnt(2)
  s_nop 0
  v_mfma_f32_16x16x16_bf16 v[28:31], v[22:23], v[84:85], v[28:31]
  v_mfma_f32_16x16x16_bf16 v[32:35], v[22:23], v[86:87], v[32:35]
  v_and_b32_dpp v22, v60, v5 quad_perm:[2,2,2,2] row_mask:0xf bank_mask:0xf
  v_and_b32_dpp v23, v60, v6 quad_perm:[2,2,2,2] row_mask:0xf bank_mask:0xf
  s_waitcnt vmcnt(1)
  s_nop 0
  v_mfma_f32_16x16x16_bf16 v[28:31], v[22:23], v[88:89], v[28:31]
  v_mfma_f32_16x16x16_bf16 v[32:35], v[22:23], v[90:91], v[32:35]
  v_and_b32_dpp v22, v60, v5 quad_perm:[3,3,3,3] row_mask:0xf bank_mask:0xf
  v_and_b32_dpp v23, v60, v6 quad_perm:[3,3,3,3] row_mask:0xf bank_mask:0xf
  s_waitcnt vmcnt(0)
  s_nop 0
  v_mfma_f32_16x16x16_bf16 v[28:31], v[22:23], v[92:93], v[28:31]
  v_mfma_f32_16x16x16_bf16 v[32:35], v[22:23], v[94:95], v[32:35]
  s_branch L_fin
L_xp0:
  v_and_b32_dpp v22, v60, v5 quad_perm:[0,0,0,0] row_mask:0xf bank_mask:0xf
  v_and_b32_dpp v23, v60, v6 quad_perm:[0,0,0,0] row_mask:0xf bank_mask:0xf
  s_nop 0
  s_nop 0
  v_mfma_f32_16x16x16_bf16 v[28:31], v[22:23], v[64:65], v[28:31]
  v_mfma_f32_16x16x16_bf16 v[32:35], v[22:23], v[66:67], v[32:35]
  v_and_b32_dpp v22, v60, v5 quad_perm:[1,1,1,1] row_mask:0xf bank_mask:0xf
  v_and_b32_dpp v23, v60, v6 quad_perm:[1,1,1,1] row_mask:0xf bank_mask:0xf
  s_nop 0
  s_nop 0
  v_mfma_f32_16x16x16_bf16 v[28:31], v[22:23], v[68:69], v[28:31]
  v_mfma_f32_16x16x16_bf16 v[32:35], v[22:23], v[70:71], v[32:35]
  v_and_b32_dpp v22, v60, v5 quad_perm:[2,2,2,2] row_mask:0xf bank_mask:0xf
  v_and_b32_dpp v23, v60, v6 quad_perm:[2,2,2,2] row_mask:0xf bank_mask:0xf
  s_nop 0
  s_nop 0
  v_mfma_f32_16x16x16_bf16 v[28:31], v[22:23], v[72:73], v[28:31]
  v_mfma_f32_16x16x16_bf16 v[32:35], v[22:23], v[74:75], v[32:35]
  v_and_b32_dpp v22, v60, v5 quad_perm:[3,3,3,3] row_mask:0xf bank_mask:0xf
  v_and_b32_dpp v23, v60, v6 quad_perm:[3,3,3,3] row_mask:0xf bank_mask:0xf
  s_nop 0
  s_nop 0
  v_mfma_f32_16x16x16_bf16 v[28:31], v[22:23], v[76:77], v[28:31]
  v_mfma_f32_16x16x16_bf16 v[32:35], v[22:23], v[78:79], v[32:35]
  v_and_b32_dpp v22, v61, v5 quad_perm:[0,0,0,0] row_mask:0xf bank_mask:0xf
  v_and_b32_dpp v23, v61, v6 quad_perm:[0,0,0,0] row_mask:0xf bank_mask:0xf
  s_waitcnt vmcnt(11)
  s_nop 0
  v_mfma_f32_16x16x16_bf16 v[28:31], v[22:23], v[80:81], v[28:31]
  v_mfma_f32_16x16x16_bf16 v[32:35], v[22:23], v[82:83], v[32:35]
  v_and_b32_dpp v22, v61, v5 quad_perm:[1,1,1,1] row_mask:0xf bank_mask:0xf
  v_and_b32_dpp v23, v61, v6 quad_perm:[1,1,1,1] row_mask:0xf bank_mask:0xf
  s_waitcnt vmcnt(10)
  s_nop 0
  v_mfma_f32_16x16x16_bf16 v[28:31], v[22:23], v[84:85], v[28:31]
  v_mfma_f32_16x16x16_bf16 v[32:35], v[22:23], v[86:87], v[32:35]
  v_and_b32_dpp v22, v61, v5 quad_perm:[2,2,2,2] row_mask:0xf bank_mask:0xf
  v_and_b32_dpp v23, v61, v6 quad_perm:[2,2,2,2] row_mask:0xf bank_mask:0xf
  s_waitcnt vmcnt(9)
  s_nop 0
  v_mfma_f32_16x16x16_bf16 v[28:31], v[22:23], v[88:89], v[28:31]
  v_mfma_f32_16x16x16_bf16 v[32:35], v[22:23], v[90:91], v[32:35]
  v_and_b32_dpp v22, v61, v5 quad_perm:[3,3,3,3] row_mask:0xf bank_mask:0xf
  v_and_b32_dpp v23, v61, v6 quad_perm:[3,3,3,3] row_mask:0xf bank_mask:0xf
  s_waitcnt vmcnt(8)
  s_nop 0
  v_mfma_f32_16x16x16_bf16 v[28:31], v[22:23], v[92:93], v[28:31]
  v_mfma_f32_16x16x16_bf16 v[32:35], v[22:23], v[94:95], v[32:35]
  v_and_b32_dpp v22, v62, v5 quad_perm:[0,0,0,0] row_mask:0xf bank_mask:0xf
  v_and_b32_dpp v23, v62, v6 quad_perm:[0,0,0,0] row_mask:0xf bank_mask:0xf
  s_waitcnt vmcnt(7)
  s_nop 0
  v_mfma_f32_16x16x16_bf16 v[28:31], v[22:23], v[96:97], v[28:31]
  v_mfma_f32_16x16x16_bf16 v[32:35], v[22:23], v[98:99], v[32:35]
  v_and_b32_dpp v22, v62, v5 quad_perm:[1,1,1,1] row_mask:0xf bank_mask:0xf
  v_and_b32_dpp v23, v62, v6 quad_perm:[1,1,1,1] row_mask:0xf bank_mask:0xf
  s_waitcnt vmcnt(6)
  s_nop 0
  v_mfma_f32_16x16x16_bf16 v[28:31], v[22:23], v[100:101], v[28:31]
  v_mfma_f32_16x16x16_bf16 v[32:35], v[22:23], v[102:103], v[32:35]
  v_and_b32_dpp v22, v62, v5 quad_perm:[2,2,2,2] row_mask:0xf bank_mask:0xf
  v_and_b32_dpp v23, v62, v6 quad_perm:[2,2,2,2] row_mask:0xf bank_mask:0xf
  s_waitcnt vmcnt(5)
  s_nop 0
  v_mfma_f32_16x16x16_bf16 v[28:31], v[22:23], v[104:105], v[28:31]
  v_mfma_f32_16x16x16_bf16 v[32:35], v[22:23], v[106:107], v[32:35]
  v_and_b32_dpp v22, v62, v5 quad_perm:[3,3,3,3] row_mask:0xf bank_mask:0xf
  v_and_b32_dpp v23, v62, v6 quad_perm:[3,3,3,3] row_mask:0xf bank_mask:0xf
  s_waitcnt vmcnt(4)
  s_nop 0
  v_mfma_f32_16x16x16_bf16 v[28:31], v[22:23], v[108:109], v[28:31]
  v_mfma_f32_16x16x16_bf16 v[32:35], v[22:23], v[110:111], v[32:35]
  v_and_b32_dpp v22, v63, v5 quad_perm:[0,0,0,0] row_mask:0xf bank_mask:0xf
  v_and_b32_dpp v23, v63, v6 quad_perm:[0,0,0,0] row_mask:0xf bank_mask:0xf
  s_waitcnt vmcnt(3)
  s_nop 0
  v_mfma_f32_16x16x16_bf16 v[28:31], v[22:23], v[112:113], v[28:31]
  v_mfma_f32_16x16x16_bf16 v[32:35], v[22:23], v[114:115], v[32:35]
  v_and_b32_dpp v22, v63, v5 quad_perm:[1,1,1,1] row_mask:0xf bank_mask:0xf
  v_and_b32_dpp v23, v63, v6 quad_perm:[1,1,1,1] row_mask:0xf bank_mask:0xf
  s_waitcnt vmcnt(2)
  s_nop 0
  v_mfma_f32_16x16x16_bf16 v[28:31], v[22:23], v[116:117], v[28:31]
  v_mfma_f32_16x16x16_bf16 v[32:35], v[22:23], v[118:119], v[32:35]
  v_and_b32_dpp v22, v63, v5 quad_perm:[2,2,2,2] row_mask:0xf bank_mask:0xf
  v_and_b32_dpp v23, v63, v6 quad_perm:[2,2,2,2] row_mask:0xf bank_mask:0xf
  s_waitcnt vmcnt(1)
  s_nop 0
  v_mfma_f32_16x16x16_bf16 v[28:31], v[22:23], v[120:121], v[28:31]
  v_mfma_f32_16x16x16_bf16 v[32:35], v[22:23], v[122:123], v[32:35]
  v_and_b32_dpp v22, v63, v5 quad_perm:[3,3,3,3] row_mask:0xf bank_mask:0xf
  v_and_b32_dpp v23, v63, v6 quad_perm:[3,3,3,3] row_mask:0xf bank_mask:0xf
  s_waitcnt vmcnt(0)
  s_nop 0
  v_mfma_f32_16x16x16_bf16 v[28:31], v[22:23], v[124:125], v[28:31]
  v_mfma_f32_16x16x16_bf16 v[32:35], v[22:23], v[126:127], v[32:35]
L_fin:
  v_add_f32_dpp v38, v38, v38 quad_perm:[1,0,3,2] row_mask:0xf bank_mask:0xf
  v_lshlrev_b32 v7, 5, v0
  v_and_b32 v4, 12, v2
  v_add_f32_dpp v38, v38, v38 quad_perm:[2,3,0,1] row_mask:0xf bank_mask:0xf
  v_mov_b32 v39, v38
  v_add_u32 v4, s7, v4
  v_lshlrev_b32 v4, 2, v4
  v_permlane16_swap_b32 v39, v38
  v_add_f32 v38, v38, v39
  v_mov_b32 v39, v38
  ds_write_b128 v7, v[28:31] offset:12288
  ds_write_b128 v7, v[32:35] offset:12304
  v_permlane32_swap_b32 v39, v38
  v_add_f32 v38, v38, v39
  ds_write_b32 v4, v36 offset:2704
  ds_write_b32 v4, v38 offset:2768
  s_mov_b32 s30, s35
  buffer_load_dwordx4 v[128:131], v43, s[48:51], s30 offen offset:0 nt
  buffer_load_dwordx4 v[132:135], v43, s[48:51], s30 offen offset:1024 nt
  buffer_load_dwordx4 v[136:139], v43, s[48:51], s30 offen offset:2048 nt
  buffer_load_dwordx4 v[140:143], v43, s[48:51], s30 offen offset:3072 nt
  s_add_u32 s30, s30, 4096
  buffer_load_dwordx4 v[144:147], v43, s[48:51], s30 offen offset:0 nt
  buffer_load_dwordx4 v[148:151], v43, s[48:51], s30 offen offset:1024 nt
  buffer_load_dwordx4 v[152:155], v43, s[48:51], s30 offen offset:2048 nt
  buffer_load_dwordx4 v[156:159], v43, s[48:51], s30 offen offset:3072 nt
  v_lshrrev_b32 v4, 5, v2
  v_and_b32 v12, 31, v2
  s_lshl_b32 s29, s7, 4
  v_lshl_add_u32 v7, v4, 7, s29
  s_lshl_b32 s29, s7, 9
  v_lshl_add_u32 v13, v12, 4, s29
  v_lshl_add_u32 v1, v4, 13, v13
  s_lshl_b32 s28, s2, 11
  s_add_u32 s28, s28, 131072
  v_lshl_add_u32 v3, v4, 19, v13
  v_add_u32 v3, s28, v3
  s_waitcnt lgkmcnt(0)
  s_barrier
  ds_read_b128 v[64:67], v7 offset:2576
  ds_read_b128 v[68:71], v7 offset:2640
  ds_read_b128 v[72:75], v1 offset:4096
  ds_read_b128 v[76:79], v1 offset:6144
  ds_read_b128 v[80:83], v1 offset:8192
  ds_read_b128 v[84:87], v1 offset:10240
  s_lshl_b32 s28, s3, 19
  s_lshl_b32 s29, s8, 16
  s_add_u32 s28, s28, s29
  s_lshl_b32 s29, s9, 7
  s_add_u32 s28, s28, s29
  s_lshl_b32 s29, s7, 5
  s_add_u32 s28, s28, s29
  s_add_u32 s28, s28, 131072
  v_lshlrev_b32 v12, 11, v12
  v_lshl_add_u32 v12, v4, 4, v12
  v_add_u32 v12, s28, v12
  s_waitcnt lgkmcnt(5)
  v_max3_f32 v36, v64, v65, v66
  v_max_f32 v36, v36, v67
  v_mul_f32 v37, s37, v36
  v_fma_f32 v64, v64, s37, -v37
  v_fma_f32 v65, v65, s37, -v37
  v_fma_f32 v66, v66, s37, -v37
  v_fma_f32 v67, v67, s37, -v37
  v_exp_f32 v64, v64
  v_exp_f32 v65, v65
  v_exp_f32 v66, v66
  v_exp_f32 v67, v67
  s_waitcnt lgkmcnt(0)
  v_mul_f32 v38, v64, v68
  v_fmac_f32 v38, v65, v69
  v_fmac_f32 v38, v66, v70
  v_fmac_f32 v38, v67, v71
  v_rcp_f32 v39, v38
  v_log_f32 v40, v38
  v_mul_f32 v72, v64, v72
  v_mul_f32 v73, v64, v73
  v_mul_f32 v74, v64, v74
  v_mul_f32 v75, v64, v75
  v_fmac_f32 v72, v65, v76
  v_fmac_f32 v73, v65, v77
  v_fmac_f32 v74, v65, v78
  v_fmac_f32 v75, v65, v79
  v_fmac_f32 v72, v66, v80
  v_fmac_f32 v73, v66, v81
  v_fmac_f32 v74, v66, v82
  v_fmac_f32 v75, v66, v83
  v_fmac_f32 v72, v67, v84
  v_fmac_f32 v73, v67, v85
  v_fmac_f32 v74, v67, v86
  v_fmac_f32 v75, v67, v87
  v_add_f32 v90, v37, v40
  v_mul_f32 v72, v39, v72
  v_mul_f32 v73, v39, v73
  v_mul_f32 v74, v39, v74
  v_mul_f32 v75, v39, v75
  v_xor_b32 v91, s6, v90
  v_cvt_pk_bf16_f32 v88, v72, v73
  v_cvt_pk_bf16_f32 v89, v74, v75
  v_bitop3_b32 v91, v91, v88, v89 bitop3:0x96
  global_store_dwordx4 v3, v[88:91], s[4:5] sc1
  s_mov_b32 s40, 0x01000100
  s_mov_b32 s41, 0x03020302
  v_mov_b32 v7, 0x0c0c0c0c
  v_bfi_b32 v8, v5, s40, v7
  v_bfi_b32 v9, v6, s40, v7
  v_bfi_b32 v10, v5, s41, v7
  v_bfi_b32 v11, v6, s41, v7
  v_lshrrev_b32 v4, 4, v2
  v_lshlrev_b32 v15, 4, v4
  s_lshl_b32 s29, s7, 4
  v_lshl_add_u32 v7, v4, 2, s29
  s_lshl_b32 s28, s3, 7
  s_lshl_b32 s29, s8, 4
  s_add_u32 s28, s28, s29
  s_add_u32 s28, s28, s9
  s_lshl_b32 s28, s28, 11
  s_add_u32 s28, s28, 1179648
  v_add_u32 v3, s28, v13
  v_mov_b32 v14, 0xff
  s_lshr_b32 s52, s6, 8
  s_lshr_b32 s53, s6, 16
  s_lshr_b32 s54, s6, 24
  s_mov_b32 s36, 131072
  s_waitcnt vmcnt(0)
L_poll1:
  global_load_dwordx4 v[16:19], v12, s[4:5] sc1
  s_sub_u32 s36, s36, 1
  s_cbranch_scc1 L_send
  s_waitcnt vmcnt(0)
  v_bitop3_b32 v40, v16, v17, v18 bitop3:0x96
  v_xor_b32 v40, v40, v19
  v_cmpx_ne_u32 vcc, s6, v40
  s_cbranch_execnz L_poll1
  s_mov_b64 exec, -1
  v_mov_b32 v19, v18
  v_mov_b32 v24, v18
  v_lshlrev_b32 v20, 16, v16
  v_and_b32 v21, 0xffff0000, v16
  v_permlane16_swap_b32 v19, v24
  v_max_f32 v19, v19, v24
  v_lshlrev_b32 v22, 16, v17
  v_and_b32 v23, 0xffff0000, v17
  v_max_f32_dpp v19, v19, v19 row_ror:1 row_mask:0xf bank_mask:0xf
  s_nop 1
  v_max_f32_dpp v19, v19, v19 row_ror:2 row_mask:0xf bank_mask:0xf
  s_nop 1
  v_max_f32_dpp v19, v19, v19 row_ror:4 row_mask:0xf bank_mask:0xf
  s_nop 1
  v_max_f32_dpp v19, v19, v19 row_ror:8 row_mask:0xf bank_mask:0xf
  v_sub_f32 v18, v18, v19
  v_exp_f32 v18, v18
  s_nop 0
  v_mov_b32 v19, v18
  v_mul_f32 v20, v18, v20
  v_mul_f32 v21, v18, v21
  v_mul_f32 v22, v18, v22
  v_mul_f32 v23, v18, v23
  v_permlane16_swap_b32 v18, v19
  v_permlane16_swap_b32 v20, v22
  v_permlane16_swap_b32 v21, v23
  v_add_f32 v18, v18, v19
  v_add_f32 v20, v20, v22
  v_add_f32 v21, v21, v23
  v_add_f32_dpp v18, v18, v18 row_ror:1 row_mask:0xf bank_mask:0xf
  v_add_f32_dpp v20, v20, v20 row_ror:1 row_mask:0xf bank_mask:0xf
  v_add_f32_dpp v21, v21, v21 row_ror:1 row_mask:0xf bank_mask:0xf
  v_add_f32_dpp v18, v18, v18 row_ror:2 row_mask:0xf bank_mask:0xf
  v_add_f32_dpp v20, v20, v20 row_ror:2 row_mask:0xf bank_mask:0xf
  v_add_f32_dpp v21, v21, v21 row_ror:2 row_mask:0xf bank_mask:0xf
  v_add_f32_dpp v18, v18, v18 row_ror:4 row_mask:0xf bank_mask:0xf
  v_add_f32_dpp v20, v20, v20 row_ror:4 row_mask:0xf bank_mask:0xf
  v_add_f32_dpp v21, v21, v21 row_ror:4 row_mask:0xf bank_mask:0xf
  v_add_f32_dpp v18, v18, v18 row_ror:8 row_mask:0xf bank_mask:0xf
  v_add_f32_dpp v20, v20, v20 row_ror:8 row_mask:0xf bank_mask:0xf
  v_add_f32_dpp v21, v21, v21 row_ror:8 row_mask:0xf bank_mask:0xf
  v_rcp_f32 v18, v18
  s_nop 0
  v_mul_f32 v20, v18, v20
  v_mul_f32 v21, v18, v21
  v_cvt_pk_bf16_f32 v20, v20, v21
  ds_write_b32 v7, v20 offset:2832
  s_waitcnt lgkmcnt(0)
  s_barrier
  ds_read_b128 v[16:19], v15 offset:2832
  s_waitcnt lgkmcnt(0)
  v_perm_b32 v20, v16, v16, v8
  v_perm_b32 v21, v16, v16, v9
  v_perm_b32 v22, v16, v16, v10
  v_perm_b32 v23, v16, v16, v11
  v_mfma_f32_16x16x16_bf16 v[40:43], v[20:21], v[128:129], 0
  v_mfma_f32_16x16x16_bf16 v[44:47], v[20:21], v[130:131], 0
  v_perm_b32 v24, v17, v17, v8
  v_perm_b32 v25, v17, v17, v9
  v_mfma_f32_16x16x16_bf16 v[40:43], v[22:23], v[132:133], v[40:43]
  v_mfma_f32_16x16x16_bf16 v[44:47], v[22:23], v[134:135], v[44:47]
  v_perm_b32 v26, v17, v17, v10
  v_perm_b32 v27, v17, v17, v11
  v_mfma_f32_16x16x16_bf16 v[40:43], v[24:25], v[136:137], v[40:43]
  v_mfma_f32_16x16x16_bf16 v[44:47], v[24:25], v[138:139], v[44:47]
  v_perm_b32 v28, v18, v18, v8
  v_perm_b32 v29, v18, v18, v9
  v_mfma_f32_16x16x16_bf16 v[40:43], v[26:27], v[140:141], v[40:43]
  v_mfma_f32_16x16x16_bf16 v[44:47], v[26:27], v[142:143], v[44:47]
  v_perm_b32 v30, v18, v18, v10
  v_perm_b32 v31, v18, v18, v11
  v_mfma_f32_16x16x16_bf16 v[40:43], v[28:29], v[144:145], v[40:43]
  v_mfma_f32_16x16x16_bf16 v[44:47], v[28:29], v[146:147], v[44:47]
  v_perm_b32 v32, v19, v19, v8
  v_perm_b32 v33, v19, v19, v9
  v_mfma_f32_16x16x16_bf16 v[40:43], v[30:31], v[148:149], v[40:43]
  v_mfma_f32_16x16x16_bf16 v[44:47], v[30:31], v[150:151], v[44:47]
  v_perm_b32 v34, v19, v19, v10
  v_perm_b32 v35, v19, v19, v11
  v_mfma_f32_16x16x16_bf16 v[40:43], v[32:33], v[152:153], v[40:43]
  v_mfma_f32_16x16x16_bf16 v[44:47], v[32:33], v[154:155], v[44:47]
  v_mfma_f32_16x16x16_bf16 v[40:43], v[34:35], v[156:157], v[40:43]
  v_mfma_f32_16x16x16_bf16 v[44:47], v[34:35], v[158:159], v[44:47]
  s_lshr_b32 s28, s2, 6
  s_lshl_b32 s28, s28, 3
  s_and_b32 s29, s2, 7
  s_add_u32 s29, s29, s28
  s_lshl_b32 s28, s29, 6
  s_lshl_b32 s30, s3, 18
  s_add_u32 s28, s28, s30
  s_lshl_b32 s30, s7, 13
  v_mov_b32_dpp v40, v44 quad_perm:[0,1,2,3] row_mask:0x2 bank_mask:0xf
  v_mov_b32_dpp v41, v45 quad_perm:[0,1,2,3] row_mask:0x2 bank_mask:0xf
  v_mov_b32_dpp v42, v46 quad_perm:[0,1,2,3] row_mask:0x2 bank_mask:0xf
  v_mov_b32_dpp v43, v47 quad_perm:[0,1,2,3] row_mask:0x2 bank_mask:0xf
  v_bfi_b32 v40, v14, s6, v40
  v_bfi_b32 v41, v14, s52, v41
  v_bfi_b32 v42, v14, s53, v42
  v_bfi_b32 v43, v14, s54, v43
  s_mov_b32 exec_hi, 0
  global_store_dwordx4 v3, v[40:43], s[4:5] sc1
  s_mov_b32 exec_hi, -1
  s_and_b32 s31, s2, 0x28
  s_cmp_lg_u32 s31, 0
  s_cbranch_scc1 L_sdone
  s_add_u32 s28, s28, s30
  s_add_u32 s28, s28, 1183744
  v_bfe_u32 v14, v2, 2, 3
  v_lshlrev_b32 v14, 15, v14
  v_lshrrev_b32 v7, 5, v2
  v_lshl_add_u32 v14, v7, 11, v14
  v_and_b32 v7, 3, v2
  v_lshl_add_u32 v14, v7, 4, v14
  v_add_u32 v14, s28, v14
  s_mov_b32 s40, 0x0c0c0400
  s_mov_b32 s41, 0x04000c0c
  v_lshlrev_b32 v12, 4, v7
  v_lshl_add_u32 v12, v4, 2, v12
  s_lshl_b32 s30, s7, 6
  v_add_u32 v12, s30, v12
  s_lshr_b32 s31, s29, 3
  s_lshl_b32 s31, s31, 8
  s_bfe_u32 s30, s29, 0x10002
  s_lshl_b32 s30, s30, 3
  s_add_u32 s31, s31, s30
  s_and_b32 s30, s29, 3
  s_lshl_b32 s30, s30, 6
  s_add_u32 s31, s31, s30
  s_lshl_b32 s30, s3, 10
  s_add_u32 s31, s31, s30
  v_lshrrev_b32 v4, 1, v2
  v_lshl_add_u32 v4, v4, 4, s31
  v_and_b32 v7, 1, v2
  v_lshl_add_u32 v4, v7, 2, v4
  v_lshlrev_b32 v7, 3, v2
  s_mov_b32 s36, 131072
  s_waitcnt vmcnt(0)
L_poll2:
  global_load_dwordx4 v[16:19], v14, s[4:5] offset:-4096 sc1
  global_load_dwordx4 v[20:23], v14, s[4:5] sc1
  s_sub_u32 s36, s36, 1
  s_cbranch_scc1 L_send
  s_waitcnt vmcnt(1)
  v_perm_b32 v40, v17, v16, s40
  v_perm_b32 v41, v19, v18, s41
  v_bitop3_b32 v40, v40, v41, s6 bitop3:0x96
  s_waitcnt vmcnt(0)
  v_perm_b32 v42, v21, v20, s40
  v_perm_b32 v41, v23, v22, s41
  v_bitop3_b32 v41, v42, v41, s6 bitop3:0x96
  v_or_b32 v40, v40, v41
  v_cmpx_ne_u32 vcc, 0, v40
  s_cbranch_execnz L_poll2
  s_mov_b64 exec, -1
  v_add_f32 v16, v16, v20
  v_add_f32 v17, v17, v21
  v_add_f32 v18, v18, v22
  v_add_f32 v19, v19, v23
  v_permlane16_swap_b32 v16, v17
  s_nop 0
  v_permlane16_swap_b32 v18, v19
  v_add_f32 v16, v16, v17
  v_add_f32 v18, v18, v19
  s_nop 1
  v_permlane32_swap_b32 v16, v18
  v_add_f32 v16, v16, v18
  s_nop 1
  v_add_f32_dpp v16, v16, v16 row_ror:4 row_mask:0xf bank_mask:0xf
  s_nop 1
  v_add_f32_dpp v16, v16, v16 row_ror:8 row_mask:0xf bank_mask:0xf
  ds_write_b32 v12, v16 offset:2896
  s_waitcnt lgkmcnt(0)
  s_barrier
  s_cmp_lg_u32 s7, 0
  s_cbranch_scc1 L_send
  s_mov_b64 exec, 0xff
  ds_read_b64 v[16:17], v7 offset:2896
  ds_read_b64 v[18:19], v7 offset:2960
  ds_read_b64 v[20:21], v7 offset:3024
  ds_read_b64 v[22:23], v7 offset:3088
  s_waitcnt lgkmcnt(0)
  v_add_f32 v16, v16, v18
  v_add_f32 v17, v17, v19
  v_add_f32 v20, v20, v22
  v_add_f32 v21, v21, v23
  v_add_f32 v16, v16, v20
  v_add_f32 v17, v17, v21
  v_cvt_pk_bf16_f32 v16, v16, v17
  global_store_dword v4, v16, s[46:47] sc1
  s_cmp_lg_u32 s2, 16
  s_cbranch_scc1 L_sdone
  s_mov_b64 exec, 1
  v_mov_b32 v12, 0
  v_mov_b32 v13, s6
  global_store_dword v12, v13, s[4:5] sc1
L_sdone:
L_send:
  s_endpgm
Lrare_d0:
  v_max_f32 v36, v36, v52
  s_nop 1
  v_max_f32_dpp v36, v36, v36 quad_perm:[1,0,3,2] row_mask:0xf bank_mask:0xf
  s_nop 1
  v_max_f32_dpp v36, v36, v36 quad_perm:[2,3,0,1] row_mask:0xf bank_mask:0xf
  v_mov_b32 v39, v36
  s_nop 1
  v_permlane16_swap_b32 v39, v36
  v_max_f32 v36, v36, v39
  v_mov_b32 v39, v36
  s_nop 1
  v_permlane32_swap_b32 v39, v36
  v_max_f32 v36, v36, v39
  v_mul_f32 v39, s37, v36
  v_sub_f32 v40, v37, v39
  v_exp_f32 v40, v40
  v_mov_b32 v37, v39
  v_mul_f32 v38, v38, v40
  v_mov_b32_dpp v39, v40 row_newbcast:0 row_mask:0x1 bank_mask:0xf
  v_mov_b32_dpp v39, v40 row_newbcast:4 row_mask:0x2 bank_mask:0xf
  v_mov_b32_dpp v39, v40 row_newbcast:8 row_mask:0x4 bank_mask:0xf
  v_mov_b32_dpp v39, v40 row_newbcast:12 row_mask:0x8 bank_mask:0xf
  v_mul_f32 v28, v28, v39
  v_mul_f32 v29, v29, v39
  v_mul_f32 v30, v30, v39
  v_mul_f32 v31, v31, v39
  v_mul_f32 v32, v32, v39
  v_mul_f32 v33, v33, v39
  v_mul_f32 v34, v34, v39
  v_mul_f32 v35, v35, v39
  s_branch Lback_d0
Lrare_d1:
  v_max_f32 v36, v36, v52
  s_nop 1
  v_max_f32_dpp v36, v36, v36 quad_perm:[1,0,3,2] row_mask:0xf bank_mask:0xf
  s_nop 1
  v_max_f32_dpp v36, v36, v36 quad_perm:[2,3,0,1] row_mask:0xf bank_mask:0xf
  v_mov_b32 v39, v36
  s_nop 1
  v_permlane16_swap_b32 v39, v36
  v_max_f32 v36, v36, v39
  v_mov_b32 v39, v36
  s_nop 1
  v_permlane32_swap_b32 v39, v36
  v_max_f32 v36, v36, v39
  v_mul_f32 v39, s37, v36
  v_sub_f32 v40, v37, v39
  v_exp_f32 v40, v40
  v_mov_b32 v37, v39
  v_mul_f32 v38, v38, v40
  v_mov_b32_dpp v39, v40 row_newbcast:0 row_mask:0x1 bank_mask:0xf
  v_mov_b32_dpp v39, v40 row_newbcast:4 row_mask:0x2 bank_mask:0xf
  v_mov_b32_dpp v39, v40 row_newbcast:8 row_mask:0x4 bank_mask:0xf
  v_mov_b32_dpp v39, v40 row_newbcast:12 row_mask:0x8 bank_mask:0xf
  v_mul_f32 v28, v28, v39
  v_mul_f32 v29, v29, v39
  v_mul_f32 v30, v30, v39
  v_mul_f32 v31, v31, v39
  v_mul_f32 v32, v32, v39
  v_mul_f32 v33, v33, v39
  v_mul_f32 v34, v34, v39
  v_mul_f32 v35, v35, v39
  s_branch Lback_d1
Lrare_e1:
  v_max_f32 v36, v36, v52
  s_nop 1
  v_max_f32_dpp v36, v36, v36 quad_perm:[1,0,3,2] row_mask:0xf bank_mask:0xf
  s_nop 1
  v_max_f32_dpp v36, v36, v36 quad_perm:[2,3,0,1] row_mask:0xf bank_mask:0xf
  v_mov_b32 v39, v36
  s_nop 1
  v_permlane16_swap_b32 v39, v36
  v_max_f32 v36, v36, v39
  v_mov_b32 v39, v36
  s_nop 1
  v_permlane32_swap_b32 v39, v36
  v_max_f32 v36, v36, v39
  v_mul_f32 v39, s37, v36
  v_sub_f32 v40, v37, v39
  v_exp_f32 v40, v40
  v_mov_b32 v37, v39
  v_mul_f32 v38, v38, v40
  v_mov_b32_dpp v39, v40 row_newbcast:0 row_mask:0x1 bank_mask:0xf
  v_mov_b32_dpp v39, v40 row_newbcast:4 row_mask:0x2 bank_mask:0xf
  v_mov_b32_dpp v39, v40 row_newbcast:8 row_mask:0x4 bank_mask:0xf
  v_mov_b32_dpp v39, v40 row_newbcast:12 row_mask:0x8 bank_mask:0xf
  v_mul_f32 v28, v28, v39
  v_mul_f32 v29, v29, v39
  v_mul_f32 v30, v30, v39
  v_mul_f32 v31, v31, v39
  v_mul_f32 v32, v32, v39
  v_mul_f32 v33, v33, v39
  v_mul_f32 v34, v34, v39
  v_mul_f32 v35, v35, v39
  s_branch Lback_e1
Lrare_e2:
  v_max_f32 v36, v36, v52
  s_nop 1
  v_max_f32_dpp v36, v36, v36 quad_perm:[1,0,3,2] row_mask:0xf bank_mask:0xf
  s_nop 1
  v_max_f32_dpp v36, v36, v36 quad_perm:[2,3,0,1] row_mask:0xf bank_mask:0xf
  v_mov_b32 v39, v36
  s_nop 1
  v_permlane16_swap_b32 v39, v36
  v_max_f32 v36, v36, v39
  v_mov_b32 v39, v36
  s_nop 1
  v_permlane32_swap_b32 v39, v36
  v_max_f32 v36, v36, v39
  v_mul_f32 v39, s37, v36
  v_sub_f32 v40, v37, v39
  v_exp_f32 v40, v40
  v_mov_b32 v37, v39
  v_mul_f32 v38, v38, v40
  v_mov_b32_dpp v39, v40 row_newbcast:0 row_mask:0x1 bank_mask:0xf
  v_mov_b32_dpp v39, v40 row_newbcast:4 row_mask:0x2 bank_mask:0xf
  v_mov_b32_dpp v39, v40 row_newbcast:8 row_mask:0x4 bank_mask:0xf
  v_mov_b32_dpp v39, v40 row_newbcast:12 row_mask:0x8 bank_mask:0xf
  v_mul_f32 v28, v28, v39
  v_mul_f32 v29, v29, v39
  v_mul_f32 v30, v30, v39
  v_mul_f32 v31, v31, v39
  v_mul_f32 v32, v32, v39
  v_mul_f32 v33, v33, v39
  v_mul_f32 v34, v34, v39
  v_mul_f32 v35, v35, v39
  s_branch Lback_e2
Lrare_e3:
  v_max_f32 v36, v36, v52
  s_nop 1
  v_max_f32_dpp v36, v36, v36 quad_perm:[1,0,3,2] row_mask:0xf bank_mask:0xf
  s_nop 1
  v_max_f32_dpp v36, v36, v36 quad_perm:[2,3,0,1] row_mask:0xf bank_mask:0xf
  v_mov_b32 v39, v36
  s_nop 1
  v_permlane16_swap_b32 v39, v36
  v_max_f32 v36, v36, v39
  v_mov_b32 v39, v36
  s_nop 1
  v_permlane32_swap_b32 v39, v36
  v_max_f32 v36, v36, v39
  v_mul_f32 v39, s37, v36
  v_sub_f32 v40, v37, v39
  v_exp_f32 v40, v40
  v_mov_b32 v37, v39
  v_mul_f32 v38, v38, v40
  v_mov_b32_dpp v39, v40 row_newbcast:0 row_mask:0x1 bank_mask:0xf
  v_mov_b32_dpp v39, v40 row_newbcast:4 row_mask:0x2 bank_mask:0xf
  v_mov_b32_dpp v39, v40 row_newbcast:8 row_mask:0x4 bank_mask:0xf
  v_mov_b32_dpp v39, v40 row_newbcast:12 row_mask:0x8 bank_mask:0xf
  v_mul_f32 v28, v28, v39
  v_mul_f32 v29, v29, v39
  v_mul_f32 v30, v30, v39
  v_mul_f32 v31, v31, v39
  v_mul_f32 v32, v32, v39
  v_mul_f32 v33, v33, v39
  v_mul_f32 v34, v34, v39
  v_mul_f32 v35, v35, v39
  s_branch Lback_e3
Lrare_e4:
  v_max_f32 v36, v36, v52
  s_nop 1
  v_max_f32_dpp v36, v36, v36 quad_perm:[1,0,3,2] row_mask:0xf bank_mask:0xf
  s_nop 1
  v_max_f32_dpp v36, v36, v36 quad_perm:[2,3,0,1] row_mask:0xf bank_mask:0xf
  v_mov_b32 v39, v36
  s_nop 1
  v_permlane16_swap_b32 v39, v36
  v_max_f32 v36, v36, v39
  v_mov_b32 v39, v36
  s_nop 1
  v_permlane32_swap_b32 v39, v36
  v_max_f32 v36, v36, v39
  v_mul_f32 v39, s37, v36
  v_sub_f32 v40, v37, v39
  v_exp_f32 v40, v40
  v_mov_b32 v37, v39
  v_mul_f32 v38, v38, v40
  v_mov_b32_dpp v39, v40 row_newbcast:0 row_mask:0x1 bank_mask:0xf
  v_mov_b32_dpp v39, v40 row_newbcast:4 row_mask:0x2 bank_mask:0xf
  v_mov_b32_dpp v39, v40 row_newbcast:8 row_mask:0x4 bank_mask:0xf
  v_mov_b32_dpp v39, v40 row_newbcast:12 row_mask:0x8 bank_mask:0xf
  v_mul_f32 v28, v28, v39
  v_mul_f32 v29, v29, v39
  v_mul_f32 v30, v30, v39
  v_mul_f32 v31, v31, v39
  v_mul_f32 v32, v32, v39
  v_mul_f32 v33, v33, v39
  v_mul_f32 v34, v34, v39
  v_mul_f32 v35, v35, v39
  s_branch Lback_e4
Lrare_e5:
  v_max_f32 v36, v36, v52
  s_nop 1
  v_max_f32_dpp v36, v36, v36 quad_perm:[1,0,3,2] row_mask:0xf bank_mask:0xf
  s_nop 1
  v_max_f32_dpp v36, v36, v36 quad_perm:[2,3,0,1] row_mask:0xf bank_mask:0xf
  v_mov_b32 v39, v36
  s_nop 1
  v_permlane16_swap_b32 v39, v36
  v_max_f32 v36, v36, v39
  v_mov_b32 v39, v36
  s_nop 1
  v_permlane32_swap_b32 v39, v36
  v_max_f32 v36, v36, v39
  v_mul_f32 v39, s37, v36
  v_sub_f32 v40, v37, v39
  v_exp_f32 v40, v40
  v_mov_b32 v37, v39
  v_mul_f32 v38, v38, v40
  v_mov_b32_dpp v39, v40 row_newbcast:0 row_mask:0x1 bank_mask:0xf
  v_mov_b32_dpp v39, v40 row_newbcast:4 row_mask:0x2 bank_mask:0xf
  v_mov_b32_dpp v39, v40 row_newbcast:8 row_mask:0x4 bank_mask:0xf
  v_mov_b32_dpp v39, v40 row_newbcast:12 row_mask:0x8 bank_mask:0xf
  v_mul_f32 v28, v28, v39
  v_mul_f32 v29, v29, v39
  v_mul_f32 v30, v30, v39
  v_mul_f32 v31, v31, v39
  v_mul_f32 v32, v32, v39
  v_mul_f32 v33, v33, v39
  v_mul_f32 v34, v34, v39
  v_mul_f32 v35, v35, v39
  s_branch Lback_e5
L_codeend:
  s_endpgm
.section .rodata,"a"
.p2align 6
.amdhsa_kernel concat_heads__gqa_block_cached__gqa_block_cached__decode_kernel
  .amdhsa_next_free_vgpr 256
  .amdhsa_next_free_sgpr 100
  .amdhsa_accum_offset 256
  .amdhsa_group_segment_fixed_size 0
  .amdhsa_kernarg_size 104
  .amdhsa_user_sgpr_count 2
  .amdhsa_user_sgpr_kernarg_segment_ptr 1
  .amdhsa_system_sgpr_workgroup_id_x 1
  .amdhsa_float_denorm_mode_32 3
.end_amdhsa_kernel
```
